```python
import torch

def _softmax(x, axis=-1):
    return torch.softmax(x, dim=axis)

def _gelu(x):
    return torch.nn.functional.gelu(x, approximate='tanh')

def _silu(x):
    return torch.nn.functional.silu(x)

def _sigmoid(x):
    return torch.sigmoid(x)

def _layernorm(x, axis=-1, eps=1e-05):
    m = x.mean(dim=axis, keepdim=True)
    v = x.var(dim=axis, keepdim=True, unbiased=False)
    return (x - m) / torch.sqrt(v + eps)

def _scatter_add(tgt, idx, src, axis=0):
    return tgt.clone().index_add_(axis, idx, src)

def _segment_sum(src, seg, n):
    out = torch.zeros((n,) + src.shape[1:], dtype=src.dtype)
    return out.index_add_(0, seg, src)

def _pad(x, pw):
    flat = tuple((v for pair in reversed(pw) for v in pair))
    return torch.nn.functional.pad(x, flat)
kernel_name = 'standalone__autoregressive_conv_wavenet__speech'

def setup_inputs():

    _w = lambda a: (lambda t: t.to(torch.bfloat16) if t.is_floating_point() else t)(torch.as_tensor(a))
    B, T, D, K = (2, 16000, 144, 5)
    return {'x': _w((lambda *s: torch.randn(*s, dtype=torch.bfloat16) * 0.1)(B, T, D)), 'w': _w((lambda *s: torch.randn(*s, dtype=torch.bfloat16) * 0.1)(K, D, 2 * D)), 'w_o': _w((lambda *s: torch.randn(*s, dtype=torch.bfloat16) * 0.05)(D, D))}

def reference(x, w, w_o):
    B, T, D = x.shape
    K = w.shape[0]
    dil = 2
    pad = (K - 1) * dil
    xp = _pad(x, ((0, 0), (pad, 0), (0, 0)))
    h = torch.einsum('btc,cd->btd', xp[:, pad:pad + T, :], w[0])
    for i in range(1, K):
        off = pad - i * dil
        h = h + torch.einsum('btc,cd->btd', xp[:, off:off + T, :], w[i])
    f = h[..., :D].clone()
    g = h[..., D:].clone()
    z = torch.tanh(f) * _sigmoid(g)
    return z @ w_o
```

```asm
; @launch grid=(250,1,1) block=(512,1,1) lds=156672
.amdgcn_target "amdgcn-amd-amdhsa--gfx950"
.text
.globl standalone__autoregressive_conv_wavenet__speech_kernel
.p2align 8
.type standalone__autoregressive_conv_wavenet__speech_kernel,@function
standalone__autoregressive_conv_wavenet__speech_kernel:
    s_load_dwordx8 s[4:11], s[0:1], 0
    s_cmp_ge_u32 s2, 250
    s_cbranch_scc1 L_end
    s_lshr_b32 s70, s2, 3
    v_cmp_gt_u32 vcc, 7, v0
    s_mul_i32 s30, s70, 768
L_codepf:
    s_getpc_b64 s[50:51]
    s_min_u32 s30, s30, L_last-L_codepf-768
    v_lshl_add_u32 v6, v0, 7, s30
    s_and_saveexec_b64 s[58:59], vcc
    s_cbranch_execz L_nopf
    global_load_dword v5, v6, s[50:51] offset:-8
L_nopf:
    s_mov_b64 exec, -1
    v_lshrrev_b32 v1, 6, v0
    v_and_b32 v88, 63, v0
    s_cmp_ge_u32 s2, 125
    v_readfirstlane_b32 s3, v1
    s_cselect_b32 s31, 125, 0
    s_cselect_b32 s37, 4608000, 0
    s_sub_u32 s31, s2, s31
    s_mul_i32 s31, s31, 36864
    s_sub_u32 s38, s31, 2304
    s_and_b32 s44, s3, 3
    s_mul_i32 s29, s44, 4608
    s_cmp_eq_u32 s3, 2
    s_cselect_b32 s45, 4, s44
    s_lshl_b32 s30, s45, 6
    v_add_u32 v2, s30, v88
    v_mul_u32_u24 v3, 1928, v2
    v_lshrrev_b32 v3, 16, v3
    v_lshrrev_b32 v2, 1, v2
    v_sub_u32 v2, v2, v3
    v_mul_u32_u24 v2, 288, v2
    v_and_b32 v3, 1, v0
    v_lshl_add_u32 v2, v3, 4, v2
    v_add_u32 v7, s38, v2
    s_lshl_b32 s39, s45, 10
    s_add_u32 m0, s39, 146944
    s_and_b32 s45, s3, 1
    s_lshl_b32 s45, s45, 1
    v_xor_b32 v2, s45, v88
    v_lshlrev_b32 v89, 4, v2
    s_mov_b32 s14, 4608000
    s_mov_b32 s15, 0x20000
    s_mov_b32 s18, 414720
    s_mov_b32 s19, 0x20000
    s_movk_i32 s30, 256
    s_waitcnt lgkmcnt(0)
    s_add_u32 s12, s4, s37
    s_addc_u32 s13, s5, 0
    s_mov_b32 s16, s6
    s_mov_b32 s17, s7
    s_cmp_ge_u32 s3, 4
    s_cbranch_scc1 L_odd
    s_cmp_lt_u32 s3, 2
    s_cbranch_scc1 L_k16
    s_mov_b32 exec_hi, 0
    s_cmp_eq_u32 s3, 2
    s_cbranch_scc1 L_odd
    s_branch L_fdone
L_k16:
    s_add_u32 m0, s29, 0
    s_add_u32 s30, s29, 405504
    s_mov_b32 exec_hi, 0
    buffer_load_dwordx4 v89, s[16:19], s30 offen lds
    s_mov_b32 exec_hi, -1
    buffer_load_dwordx4 v89, s[16:19], s30 offen offset:512 lds
    buffer_load_dwordx4 v89, s[16:19], s30 offen offset:1536 lds
    buffer_load_dwordx4 v89, s[16:19], s30 offen offset:2560 lds
    buffer_load_dwordx4 v89, s[16:19], s30 offen offset:3584 lds
    s_branch L_fdone
L_odd:
    buffer_load_dwordx4 v7, s[12:15], s30 offen lds
L_fdone:
    s_mov_b64 exec, -1
    s_mul_i32 s28, s3, 4608
    v_lshrrev_b32 v6, 2, v88
    v_mul_u32_u24 v6, 288, v6
    v_and_b32 v3, 3, v0
    v_lshl_add_u32 v6, v3, 4, v6
    s_add_u32 s30, s28, s38
    v_add_u32 v104, s30, v6
    s_mul_i32 s43, s3, 1056
    s_add_u32 s43, s43, 110592
    s_bfe_u32 s49, s3, 0x10001
    s_mul_i32 s49, s49, 73728
    s_add_u32 s49, s49, s29
    v_and_b32 v1, 15, v88
    v_lshrrev_b32 v2, 4, v88
    v_add_u32 v4, 4, v1
    v_and_b32 v3, 7, v4
    v_bfe_u32 v4, v4, 3, 1
    v_lshrrev_b32 v117, 2, v1
    v_and_b32 v118, 3, v1
    v_and_b32 v7, 1, v2
    v_lshrrev_b32 v1, 1, v2
    v_lshl_add_u32 v116, v2, 3, v117
    v_mul_u32_u24 v116, 576, v116
    v_lshl_add_u32 v116, v118, 3, v116
    v_lshl_add_u32 v6, v2, 2, v117
    v_mul_u32_u24 v6, 288, v6
    v_lshl_add_u32 v106, v118, 3, v6
    v_lshlrev_b32 v117, 5, v7
    s_lshl_b32 s45, s3, 5
    v_xor_b32 v118, s45, v117
    v_add_u32 v91, v116, v118
    s_add_u32 s45, s45, 288
    v_xor_b32 v118, s45, v117
    v_add_u32 v92, v116, v118
    v_xor_b32 v118, 256, v117
    v_add_u32 v93, v116, v118
    v_xor_b32 v118, 544, v117
    v_add_u32 v94, v116, v118
    v_mul_u32_u24 v6, 544, v3
    v_lshl_add_u32 v6, v4, 5, v6
    v_lshl_add_u32 v6, v7, 4, v6
    v_add_u32 v6, 146944, v6
    v_lshl_add_u32 v103, v1, 3, v6
    v_lshlrev_b32 v116, 6, v1
    v_sub_u32 v120, v6, v116
    v_lshlrev_b32 v116, 5, v1
    v_sub_u32 v121, v120, v116
    v_mul_u32_u24 v7, 1056, v3
    v_lshl_add_u32 v7, v4, 6, v7
    v_lshl_add_u32 v7, v2, 4, v7
    v_add_u32 v99, 110592, v7
    v_mul_u32_u24 v7, 6912, v1
    v_sub_u32 v116, v91, v7
    v_sub_u32 v117, v92, v7
    v_add_u32 v95, 55296, v91
    v_add_u32 v96, 55296, v92
    s_cmp_ge_u32 s3, 4
    s_cbranch_scc0 L_grpA
    s_barrier
    s_setprio 3
    s_add_u32 m0, s29, 18432
    s_add_u32 s30, s49, 73728
    s_mov_b32 exec_hi, 0
    buffer_load_dwordx4 v89, s[16:19], s30 offen lds
    s_mov_b32 exec_hi, -1
    buffer_load_dwordx4 v89, s[16:19], s30 offen offset:512 lds
    buffer_load_dwordx4 v89, s[16:19], s30 offen offset:1536 lds
    buffer_load_dwordx4 v89, s[16:19], s30 offen offset:2560 lds
    buffer_load_dwordx4 v89, s[16:19], s30 offen offset:3584 lds
    s_lshl2_add_u32 s30, s70, s44
    s_mul_i32 s30, s30, 12
    v_add_u32 v6, s30, v88
    v_mul_u32_u24 v7, 3641, v6
    v_lshrrev_b32 v7, 20, v7
    v_mul_u32_u24 v7, 46080, v7
    v_lshl_add_u32 v6, v6, 7, v7
    s_mov_b32 s30, 0
    s_mov_b64 exec, 4095
    buffer_load_dword v5, v6, s[16:19], s30 offen
    s_mov_b64 exec, -1
    s_setprio 1
    s_branch L_grpB
L_grpA:
    v_sub_u32 v118, v93, v7
    v_sub_u32 v119, v94, v7
    s_lshl_b32 s45, s44, 7
    v_add_u32 v100, s45, v103
    s_lshl_b32 s45, s44, 1
    s_add_u32 s45, s45, 2
    v_sub_u32 v7, s45, v1
    v_lshrrev_b32 v122, 3, v7
    v_lshl_add_u32 v7, v7, 6, v6
    v_lshl_add_u32 v122, v122, 5, v7
    s_lshl_b32 s45, s44, 1
    s_add_u32 s45, s45, 3
    v_sub_u32 v7, s45, v1
    v_lshrrev_b32 v123, 3, v7
    v_lshl_add_u32 v7, v7, 6, v6
    v_lshl_add_u32 v123, v123, 5, v7
    s_lshl_b32 s45, s44, 1
    s_add_u32 s45, s45, 4
    v_sub_u32 v7, s45, v1
    v_lshrrev_b32 v124, 3, v7
    v_lshl_add_u32 v7, v7, 6, v6
    v_lshl_add_u32 v124, v124, 5, v7
    s_lshl_b32 s45, s44, 1
    s_add_u32 s45, s45, 5
    v_sub_u32 v7, s45, v1
    v_lshrrev_b32 v125, 3, v7
    v_lshl_add_u32 v7, v7, 6, v6
    v_lshl_add_u32 v125, v125, 5, v7
    s_barrier
    s_setprio 2
    s_add_u32 m0, s29, 36864
    s_add_u32 s30, s49, 239616
    s_mov_b32 exec_hi, 0
    buffer_load_dwordx4 v89, s[16:19], s30 offen lds
    s_mov_b32 exec_hi, -1
    buffer_load_dwordx4 v89, s[16:19], s30 offen offset:512 lds
    buffer_load_dwordx4 v89, s[16:19], s30 offen offset:1536 lds
    buffer_load_dwordx4 v89, s[16:19], s30 offen offset:2560 lds
    buffer_load_dwordx4 v89, s[16:19], s30 offen offset:3584 lds
    s_waitcnt vmcnt(5)
    s_barrier
    ds_read_b64_tr_b16 a[0:1], v116 offset:0
    ds_read_b64 a[4:5], v103 offset:0
    ds_read_b64 a[8:9], v103 offset:64
    ds_read_b64 a[12:13], v103 offset:128
    ds_read_b64 a[16:17], v103 offset:192
    ds_read_b64 a[20:21], v103 offset:256
    s_waitcnt lgkmcnt(4)
    v_mfma_f32_16x16x16_bf16 v[8:11], a[0:1], a[4:5], 0
    ds_read_b64 a[24:25], v103 offset:320
    ds_read_b64 a[28:29], v103 offset:384
    ds_read_b64 a[32:33], v103 offset:448
    s_waitcnt lgkmcnt(6)
    v_mfma_f32_16x16x16_bf16 v[12:15], a[0:1], a[8:9], 0
    ds_read_b64_tr_b16 a[36:37], v117 offset:0
    s_waitcnt lgkmcnt(6)
    v_mfma_f32_16x16x16_bf16 v[16:19], a[0:1], a[12:13], 0
    ds_read_b64_tr_b16 a[40:41], v118 offset:0
    s_waitcnt lgkmcnt(6)
    v_mfma_f32_16x16x16_bf16 v[20:23], a[0:1], a[16:17], 0
    ds_read_b64 a[44:45], v100 offset:0
    s_waitcnt lgkmcnt(6)
    v_mfma_f32_16x16x16_bf16 v[24:27], a[0:1], a[20:21], 0
    ds_read_b64 a[48:49], v100 offset:64
    s_waitcnt lgkmcnt(6)
    v_mfma_f32_16x16x16_bf16 v[28:31], a[0:1], a[24:25], 0
    ds_read_b64_tr_b16 a[52:53], v119 offset:0
    s_waitcnt lgkmcnt(6)
    v_mfma_f32_16x16x16_bf16 v[32:35], a[0:1], a[28:29], 0
    ds_read_b128 a[56:59], v120 offset:256
    s_waitcnt lgkmcnt(6)
    v_mfma_f32_16x16x16_bf16 v[36:39], a[0:1], a[32:33], 0
    ds_read_b128 a[60:63], v120 offset:320
    s_waitcnt lgkmcnt(6)
    v_mfma_f32_16x16x16_bf16 v[40:43], a[36:37], a[4:5], 0
    ds_read_b128 a[64:67], v120 offset:384
    v_mfma_f32_16x16x16_bf16 v[44:47], a[36:37], a[8:9], 0
    ds_read_b128 a[68:71], v120 offset:448
    v_mfma_f32_16x16x16_bf16 v[48:51], a[36:37], a[12:13], 0
    ds_read_b128 a[72:75], v121 offset:544
    v_mfma_f32_16x16x16_bf16 v[52:55], a[36:37], a[16:17], 0
    ds_read_b128 a[76:79], v120 offset:608
    v_mfma_f32_16x16x16_bf16 v[56:59], a[36:37], a[20:21], 0
    ds_read_b128 a[80:83], v120 offset:672
    ds_read_b128 a[84:87], v120 offset:736
    s_add_u32 m0, s43, 0
    s_movk_i32 s30, 0
    buffer_load_dwordx4 v104, s[12:15], s30 offen lds
    s_mov_b32 s48, 119040
    s_movk_i32 s30, 23040
    s_cmp_eq_u32 s3, 3
    s_cselect_b32 m0, s48, 151552
    s_cselect_b32 s30, s30, 0x7ff00000
    v_add_u32 v7, s30, v104
    s_mov_b32 exec_hi, 0
    buffer_load_dwordx4 v7, s[12:15], 0 offen lds
    s_mov_b32 exec_hi, -1
    s_waitcnt lgkmcnt(8)
    s_barrier
    v_mfma_f32_16x16x16_bf16 v[60:63], a[36:37], a[24:25], 0
    ds_read_b64_tr_b16 a[88:89], v91 offset:18432
    ds_read_b64_tr_b16 a[90:91], v91 offset:20736
    v_mfma_f32_16x16x16_bf16 v[64:67], a[36:37], a[28:29], 0
    ds_read_b64_tr_b16 a[92:93], v92 offset:18432
    v_mfma_f32_16x16x16_bf16 v[68:71], a[36:37], a[32:33], 0
    ds_read_b64_tr_b16 a[94:95], v92 offset:20736
    v_mfma_f32_16x16x16_bf16 v[72:75], a[40:41], a[44:45], 0
    ds_read_b64_tr_b16 a[96:97], v93 offset:18432
    v_mfma_f32_16x16x16_bf16 v[76:79], a[40:41], a[48:49], 0
    ds_read_b64_tr_b16 a[98:99], v93 offset:20736
    v_mfma_f32_16x16x16_bf16 v[80:83], a[52:53], a[44:45], 0
    ds_read_b128 a[100:103], v124
    v_mfma_f32_16x16x16_bf16 v[84:87], a[52:53], a[48:49], 0
    s_waitcnt lgkmcnt(8)
    ds_read_b128 a[104:107], v125
    s_waitcnt lgkmcnt(6)
    v_mfma_f32_16x16x32_bf16 v[8:11], a[88:91], a[56:59], v[8:11]
    ds_read_b64_tr_b16 a[108:109], v94 offset:18432
    v_mfma_f32_16x16x32_bf16 v[12:15], a[88:91], a[60:63], v[12:15]
    ds_read_b64_tr_b16 a[110:111], v94 offset:20736
    v_mfma_f32_16x16x32_bf16 v[16:19], a[88:91], a[64:67], v[16:19]
    ds_read_b128 a[112:115], v120 offset:128
    v_mfma_f32_16x16x32_bf16 v[20:23], a[88:91], a[68:71], v[20:23]
    ds_read_b128 a[116:119], v120 offset:192
    v_mfma_f32_16x16x32_bf16 v[24:27], a[88:91], a[72:75], v[24:27]
    ds_read_b128 a[120:123], v122
    v_mfma_f32_16x16x32_bf16 v[28:31], a[88:91], a[76:79], v[28:31]
    ds_read_b128 a[124:127], v123
    v_mfma_f32_16x16x32_bf16 v[32:35], a[88:91], a[80:83], v[32:35]
    v_add_u32 v97, 55296, v93
    v_mfma_f32_16x16x32_bf16 v[36:39], a[88:91], a[84:87], v[36:39]
    v_add_u32 v98, 55296, v94
    s_waitcnt lgkmcnt(10)
    v_mfma_f32_16x16x32_bf16 v[40:43], a[92:95], a[56:59], v[40:43]
    s_add_u32 s45, s44, 2
    v_mfma_f32_16x16x32_bf16 v[44:47], a[92:95], a[60:63], v[44:47]
    s_lshr_b32 s68, s45, 2
    v_mfma_f32_16x16x32_bf16 v[48:51], a[92:95], a[64:67], v[48:51]
    s_lshl3_add_u32 s45, s45, s68
    v_mfma_f32_16x16x32_bf16 v[52:55], a[92:95], a[68:71], v[52:55]
    s_lshl_b32 s45, s45, 5
    v_mfma_f32_16x16x32_bf16 v[56:59], a[92:95], a[72:75], v[56:59]
    v_add_u32 v102, s45, v99
    s_add_u32 m0, s29, 55296
    s_add_u32 s30, s29, 0
    s_mov_b32 exec_hi, 0
    buffer_load_dwordx4 v89, s[16:19], s30 offen lds
    s_mov_b32 exec_hi, -1
    buffer_load_dwordx4 v89, s[16:19], s30 offen offset:512 lds
    buffer_load_dwordx4 v89, s[16:19], s30 offen offset:1536 lds
    buffer_load_dwordx4 v89, s[16:19], s30 offen offset:2560 lds
    buffer_load_dwordx4 v89, s[16:19], s30 offen offset:3584 lds
    s_waitcnt vmcnt(7) lgkmcnt(4)
    s_barrier
    v_mfma_f32_16x16x32_bf16 v[60:63], a[92:95], a[76:79], v[60:63]
    ds_read_b64_tr_b16 a[0:1], v91 offset:36864
    ds_read_b64_tr_b16 a[2:3], v91 offset:39168
    v_mfma_f32_16x16x32_bf16 v[64:67], a[92:95], a[80:83], v[64:67]
    ds_read_b64_tr_b16 a[4:5], v92 offset:36864
    v_mfma_f32_16x16x32_bf16 v[68:71], a[92:95], a[84:87], v[68:71]
    ds_read_b64_tr_b16 a[6:7], v92 offset:39168
    v_mfma_f32_16x16x32_bf16 v[72:75], a[96:99], a[100:103], v[72:75]
    ds_read_b64_tr_b16 a[8:9], v93 offset:36864
    v_mfma_f32_16x16x32_bf16 v[76:79], a[96:99], a[104:107], v[76:79]
    ds_read_b64_tr_b16 a[10:11], v93 offset:39168
    v_mfma_f32_16x16x32_bf16 v[80:83], a[108:111], a[100:103], v[80:83]
    ds_read_b64_tr_b16 a[12:13], v94 offset:36864
    v_mfma_f32_16x16x32_bf16 v[84:87], a[108:111], a[104:107], v[84:87]
    ds_read_b64_tr_b16 a[14:15], v94 offset:39168
    s_waitcnt lgkmcnt(6)
    v_mfma_f32_16x16x32_bf16 v[8:11], a[0:3], a[112:115], v[8:11]
    s_add_u32 s45, s44, 1
    v_mfma_f32_16x16x32_bf16 v[12:15], a[0:3], a[116:119], v[12:15]
    s_lshr_b32 s68, s45, 2
    v_mfma_f32_16x16x32_bf16 v[16:19], a[0:3], a[56:59], v[16:19]
    s_lshl3_add_u32 s45, s45, s68
    v_mfma_f32_16x16x32_bf16 v[20:23], a[0:3], a[60:63], v[20:23]
    s_lshl_b32 s45, s45, 5
    v_mfma_f32_16x16x32_bf16 v[24:27], a[0:3], a[64:67], v[24:27]
    v_add_u32 v101, s45, v99
    v_mfma_f32_16x16x32_bf16 v[28:31], a[0:3], a[68:71], v[28:31]
    s_add_u32 s45, s44, 0
    v_mfma_f32_16x16x32_bf16 v[32:35], a[0:3], a[72:75], v[32:35]
    s_lshr_b32 s68, s45, 2
    v_mfma_f32_16x16x32_bf16 v[36:39], a[0:3], a[76:79], v[36:39]
    s_lshl3_add_u32 s45, s45, s68
    s_waitcnt lgkmcnt(4)
    v_mfma_f32_16x16x32_bf16 v[40:43], a[4:7], a[112:115], v[40:43]
    s_lshl_b32 s45, s45, 5
    v_mfma_f32_16x16x32_bf16 v[44:47], a[4:7], a[116:119], v[44:47]
    v_add_u32 v100, s45, v99
    v_mfma_f32_16x16x32_bf16 v[48:51], a[4:7], a[56:59], v[48:51]
    s_mov_b32 s20, s8
    s_add_u32 m0, s29, 92160
    s_add_u32 s30, s29, 165888
    s_mov_b32 exec_hi, 0
    buffer_load_dwordx4 v89, s[16:19], s30 offen lds
    s_mov_b32 exec_hi, -1
    buffer_load_dwordx4 v89, s[16:19], s30 offen offset:512 lds
    buffer_load_dwordx4 v89, s[16:19], s30 offen offset:1536 lds
    buffer_load_dwordx4 v89, s[16:19], s30 offen offset:2560 lds
    buffer_load_dwordx4 v89, s[16:19], s30 offen offset:3584 lds
    s_waitcnt vmcnt(5) lgkmcnt(0)
    s_barrier
    v_mfma_f32_16x16x32_bf16 v[52:55], a[4:7], a[60:63], v[52:55]
    ds_read_b64_tr_b16 a[16:17], v95 offset:0
    ds_read_b64_tr_b16 a[18:19], v95 offset:2304
    ds_read_b128 a[20:23], v99 offset:512
    v_mfma_f32_16x16x32_bf16 v[56:59], a[4:7], a[64:67], v[56:59]
    ds_read_b128 a[24:27], v99 offset:640
    v_mfma_f32_16x16x32_bf16 v[60:63], a[4:7], a[68:71], v[60:63]
    ds_read_b128 a[28:31], v99 offset:768
    v_mfma_f32_16x16x32_bf16 v[64:67], a[4:7], a[72:75], v[64:67]
    ds_read_b128 a[36:39], v99 offset:896
    v_mfma_f32_16x16x32_bf16 v[68:71], a[4:7], a[76:79], v[68:71]
    ds_read_b128 a[32:35], v99 offset:1056
    v_mfma_f32_16x16x32_bf16 v[72:75], a[8:11], a[120:123], v[72:75]
    ds_read_b128 a[40:43], v99 offset:1184
    v_mfma_f32_16x16x32_bf16 v[76:79], a[8:11], a[124:127], v[76:79]
    ds_read_b128 a[44:47], v99 offset:1312
    v_mfma_f32_16x16x32_bf16 v[80:83], a[12:15], a[120:123], v[80:83]
    ds_read_b128 a[52:55], v99 offset:1440
    v_mfma_f32_16x16x32_bf16 v[84:87], a[12:15], a[124:127], v[84:87]
    ds_read_b64_tr_b16 a[48:49], v96 offset:0
    ds_read_b64_tr_b16 a[50:51], v96 offset:2304
    s_waitcnt lgkmcnt(9)
    v_mfma_f32_16x16x32_bf16 v[8:11], a[16:19], a[20:23], v[8:11]
    ds_read_b64_tr_b16 a[88:89], v97 offset:0
    s_waitcnt lgkmcnt(9)
    v_mfma_f32_16x16x32_bf16 v[12:15], a[16:19], a[24:27], v[12:15]
    ds_read_b64_tr_b16 a[90:91], v97 offset:2304
    s_waitcnt lgkmcnt(9)
    v_mfma_f32_16x16x32_bf16 v[16:19], a[16:19], a[28:31], v[16:19]
    ds_read_b128 a[80:83], v102 offset:0
    s_waitcnt lgkmcnt(9)
    v_mfma_f32_16x16x32_bf16 v[20:23], a[16:19], a[36:39], v[20:23]
    ds_read_b128 a[92:95], v102 offset:128
    s_waitcnt lgkmcnt(9)
    v_mfma_f32_16x16x32_bf16 v[24:27], a[16:19], a[32:35], v[24:27]
    ds_read_b64_tr_b16 a[84:85], v98 offset:0
    s_waitcnt lgkmcnt(9)
    v_mfma_f32_16x16x32_bf16 v[28:31], a[16:19], a[40:43], v[28:31]
    ds_read_b64_tr_b16 a[86:87], v98 offset:2304
    s_waitcnt lgkmcnt(9)
    v_mfma_f32_16x16x32_bf16 v[32:35], a[16:19], a[44:47], v[32:35]
    ds_read_b128 a[96:99], v99 offset:384
    s_waitcnt lgkmcnt(9)
    v_mfma_f32_16x16x32_bf16 v[36:39], a[16:19], a[52:55], v[36:39]
    ds_read_b128 a[100:103], v101 offset:128
    s_waitcnt lgkmcnt(8)
    v_mfma_f32_16x16x32_bf16 v[40:43], a[48:51], a[20:23], v[40:43]
    ds_read_b128 a[108:111], v99 offset:256
    v_mfma_f32_16x16x32_bf16 v[44:47], a[48:51], a[24:27], v[44:47]
    ds_read_b128 a[104:107], v101 offset:0
    v_mfma_f32_16x16x32_bf16 v[48:51], a[48:51], a[28:31], v[48:51]
    ds_read_b128 a[0:3], v99 offset:128
    s_add_u32 m0, s29, 18432
    s_add_u32 s30, s29, 331776
    s_mov_b32 exec_hi, 0
    buffer_load_dwordx4 v89, s[16:19], s30 offen lds
    s_mov_b32 exec_hi, -1
    buffer_load_dwordx4 v89, s[16:19], s30 offen offset:512 lds
    buffer_load_dwordx4 v89, s[16:19], s30 offen offset:1536 lds
    buffer_load_dwordx4 v89, s[16:19], s30 offen offset:2560 lds
    buffer_load_dwordx4 v89, s[16:19], s30 offen offset:3584 lds
    s_add_u32 m0, s43, 8960
    s_movk_i32 s30, 64
    buffer_load_dwordx4 v104, s[12:15], s30 offen lds
    s_mul_i32 s48, s3, 8960
    s_and_b32 s30, s3, 2
    s_lshl_b32 s30, s30, 8
    s_add_u32 s48, s48, s30
    s_add_u32 s48, s48, 119040
    s_mul_i32 s30, s3, -4544
    s_add_u32 s30, s30, 36864
    s_cmp_lg_u32 s3, 0
    s_cselect_b32 m0, s48, 151552
    s_cselect_b32 s30, s30, 0x7ff00000
    v_add_u32 v7, s30, v104
    s_mov_b32 exec_hi, 0
    buffer_load_dwordx4 v7, s[12:15], 0 offen lds
    s_mov_b32 exec_hi, -1
    s_waitcnt vmcnt(7) lgkmcnt(5)
    s_barrier
    v_mfma_f32_16x16x32_bf16 v[52:55], a[48:51], a[36:39], v[52:55]
    ds_read_b64_tr_b16 a[112:113], v95 offset:18432
    ds_read_b64_tr_b16 a[114:115], v95 offset:20736
    v_mfma_f32_16x16x32_bf16 v[56:59], a[48:51], a[32:35], v[56:59]
    ds_read_b64_tr_b16 a[116:117], v96 offset:18432
    v_mfma_f32_16x16x32_bf16 v[60:63], a[48:51], a[40:43], v[60:63]
    ds_read_b64_tr_b16 a[118:119], v96 offset:20736
    v_mfma_f32_16x16x32_bf16 v[64:67], a[48:51], a[44:47], v[64:67]
    ds_read_b64_tr_b16 a[56:57], v97 offset:18432
    v_mfma_f32_16x16x32_bf16 v[68:71], a[48:51], a[52:55], v[68:71]
    ds_read_b64_tr_b16 a[58:59], v97 offset:20736
    v_mfma_f32_16x16x32_bf16 v[72:75], a[88:91], a[80:83], v[72:75]
    ds_read_b64_tr_b16 a[60:61], v98 offset:18432
    v_mfma_f32_16x16x32_bf16 v[76:79], a[88:91], a[92:95], v[76:79]
    ds_read_b64_tr_b16 a[62:63], v98 offset:20736
    v_mfma_f32_16x16x32_bf16 v[80:83], a[84:87], a[80:83], v[80:83]
    ds_read_b64_tr_b16 a[64:65], v95 offset:36864
    v_mfma_f32_16x16x32_bf16 v[84:87], a[84:87], a[92:95], v[84:87]
    ds_read_b64_tr_b16 a[66:67], v95 offset:39168
    s_waitcnt lgkmcnt(8)
    v_mfma_f32_16x16x32_bf16 v[8:11], a[112:115], a[96:99], v[8:11]
    ds_read_b64_tr_b16 a[68:69], v96 offset:36864
    v_mfma_f32_16x16x32_bf16 v[12:15], a[112:115], a[20:23], v[12:15]
    ds_read_b64_tr_b16 a[70:71], v96 offset:39168
    v_mfma_f32_16x16x32_bf16 v[16:19], a[112:115], a[24:27], v[16:19]
    ds_read_b64_tr_b16 a[72:73], v97 offset:36864
    v_mfma_f32_16x16x32_bf16 v[20:23], a[112:115], a[28:31], v[20:23]
    ds_read_b64_tr_b16 a[74:75], v97 offset:39168
    v_mfma_f32_16x16x32_bf16 v[24:27], a[112:115], a[36:39], v[24:27]
    ds_read_b64_tr_b16 a[4:5], v98 offset:36864
    v_mfma_f32_16x16x32_bf16 v[28:31], a[112:115], a[32:35], v[28:31]
    ds_read_b64_tr_b16 a[6:7], v98 offset:39168
    v_mfma_f32_16x16x32_bf16 v[32:35], a[112:115], a[40:43], v[32:35]
    ds_read_b128 a[76:79], v100 offset:128
    v_mfma_f32_16x16x32_bf16 v[36:39], a[112:115], a[44:47], v[36:39]
    s_waitcnt lgkmcnt(8)
    ds_read_b128 a[8:11], v99 offset:0
    v_mfma_f32_16x16x32_bf16 v[40:43], a[116:119], a[96:99], v[40:43]
    s_mov_b32 s21, s9
    v_mfma_f32_16x16x32_bf16 v[44:47], a[116:119], a[20:23], v[44:47]
    s_mov_b32 s22, 41472
    v_mfma_f32_16x16x32_bf16 v[48:51], a[116:119], a[24:27], v[48:51]
    s_mov_b32 s23, 0x20000
    v_mfma_f32_16x16x32_bf16 v[52:55], a[116:119], a[28:31], v[52:55]
    v_lshlrev_b32 v90, 4, v88
    v_mfma_f32_16x16x32_bf16 v[56:59], a[116:119], a[36:39], v[56:59]
    s_mov_b32 s32, 0xbfb8aa3b
    v_mfma_f32_16x16x32_bf16 v[60:63], a[116:119], a[32:35], v[60:63]
    s_mov_b32 s33, 0xbfb8aa3b
    v_mfma_f32_16x16x32_bf16 v[64:67], a[116:119], a[40:43], v[64:67]
    s_mov_b32 s34, 0x2f800000
    v_mfma_f32_16x16x32_bf16 v[68:71], a[116:119], a[44:47], v[68:71]
    s_mov_b32 s35, 0x2f800000
    v_mfma_f32_16x16x32_bf16 v[72:75], a[56:59], a[100:103], v[72:75]
    ds_read_b128 a[120:123], v100 offset:0
    v_mfma_f32_16x16x32_bf16 v[76:79], a[56:59], a[80:83], v[76:79]
    s_mov_b32 s52, 0xc038aa3b
    v_mfma_f32_16x16x32_bf16 v[80:83], a[60:63], a[100:103], v[80:83]
    s_mov_b32 s53, 0xc038aa3b
    v_mfma_f32_16x16x32_bf16 v[84:87], a[60:63], a[80:83], v[84:87]
    s_mov_b32 s54, 0x30000000
    s_add_u32 m0, s29, 36864
    s_add_u32 s30, s29, 18432
    s_mov_b32 exec_hi, 0
    buffer_load_dwordx4 v89, s[16:19], s30 offen lds
    s_mov_b32 exec_hi, -1
    buffer_load_dwordx4 v89, s[16:19], s30 offen offset:512 lds
    buffer_load_dwordx4 v89, s[16:19], s30 offen offset:1536 lds
    buffer_load_dwordx4 v89, s[16:19], s30 offen offset:2560 lds
    buffer_load_dwordx4 v89, s[16:19], s30 offen offset:3584 lds
    s_waitcnt vmcnt(7) lgkmcnt(3)
    s_barrier
    v_mfma_f32_16x16x32_bf16 v[8:11], a[64:67], a[108:111], v[8:11]
    ds_read_b64_tr_b16 a[12:13], v91 offset:0
    v_mfma_f32_16x16x32_bf16 v[12:15], a[64:67], a[96:99], v[12:15]
    ds_read_b64_tr_b16 a[14:15], v91 offset:2304
    v_mfma_f32_16x16x32_bf16 v[16:19], a[64:67], a[20:23], v[16:19]
    ds_read_b64_tr_b16 a[124:125], v92 offset:0
    v_mfma_f32_16x16x32_bf16 v[20:23], a[64:67], a[24:27], v[20:23]
    ds_read_b64_tr_b16 a[126:127], v92 offset:2304
    v_mfma_f32_16x16x32_bf16 v[24:27], a[64:67], a[28:31], v[24:27]
    ds_read_b64_tr_b16 a[16:17], v93 offset:0
    v_mfma_f32_16x16x32_bf16 v[28:31], a[64:67], a[36:39], v[28:31]
    ds_read_b64_tr_b16 a[18:19], v93 offset:2304
    v_mfma_f32_16x16x32_bf16 v[32:35], a[64:67], a[32:35], v[32:35]
    ds_read_b64_tr_b16 a[48:49], v94 offset:0
    v_mfma_f32_16x16x32_bf16 v[36:39], a[64:67], a[40:43], v[36:39]
    ds_read_b64_tr_b16 a[50:51], v94 offset:2304
    v_mfma_f32_16x16x32_bf16 v[40:43], a[68:71], a[108:111], v[40:43]
    ds_read_b64_tr_b16 a[52:53], v91 offset:18432
    v_mfma_f32_16x16x32_bf16 v[44:47], a[68:71], a[96:99], v[44:47]
    ds_read_b64_tr_b16 a[54:55], v91 offset:20736
    v_mfma_f32_16x16x32_bf16 v[48:51], a[68:71], a[20:23], v[48:51]
    ds_read_b64_tr_b16 a[88:89], v92 offset:18432
    v_mfma_f32_16x16x32_bf16 v[52:55], a[68:71], a[24:27], v[52:55]
    ds_read_b64_tr_b16 a[90:91], v92 offset:20736
    v_mfma_f32_16x16x32_bf16 v[56:59], a[68:71], a[28:31], v[56:59]
    s_waitcnt lgkmcnt(8)
    ds_read_b64_tr_b16 a[84:85], v93 offset:18432
    v_mfma_f32_16x16x32_bf16 v[60:63], a[68:71], a[36:39], v[60:63]
    ds_read_b64_tr_b16 a[86:87], v93 offset:20736
    v_mfma_f32_16x16x32_bf16 v[64:67], a[68:71], a[32:35], v[64:67]
    ds_read_b64_tr_b16 a[92:93], v94 offset:18432
    v_mfma_f32_16x16x32_bf16 v[68:71], a[68:71], a[40:43], v[68:71]
    ds_read_b64_tr_b16 a[94:95], v94 offset:20736
    v_mfma_f32_16x16x32_bf16 v[72:75], a[72:75], a[104:107], v[72:75]
    s_mov_b32 s55, 0x30000000
    v_mfma_f32_16x16x32_bf16 v[76:79], a[72:75], a[100:103], v[76:79]
    s_lshr_b32 s69, s3, 1
    v_mfma_f32_16x16x32_bf16 v[80:83], a[4:7], a[104:107], v[80:83]
    s_lshl_b32 s45, s44, 6
    v_mfma_f32_16x16x32_bf16 v[84:87], a[4:7], a[100:103], v[84:87]
    v_add_u32 v106, 92160, v106
    v_mfma_f32_16x16x32_bf16 v[8:11], a[12:15], a[0:3], v[8:11]
    v_add_u32 v105, s45, v106
    v_mfma_f32_16x16x32_bf16 v[12:15], a[12:15], a[108:111], v[12:15]
    v_mul_u32_u24 v3, 1168, v3
    v_mfma_f32_16x16x32_bf16 v[16:19], a[12:15], a[96:99], v[16:19]
    v_mul_u32_u24 v4, 288, v4
    v_mfma_f32_16x16x32_bf16 v[20:23], a[12:15], a[20:23], v[20:23]
    v_lshl_add_u32 v3, v2, 3, v3
    v_mfma_f32_16x16x32_bf16 v[24:27], a[12:15], a[24:27], v[24:27]
    v_add_u32 v3, v3, v4
    v_mfma_f32_16x16x32_bf16 v[28:31], a[12:15], a[28:31], v[28:31]
    s_and_b32 s47, s3, 1
    v_mfma_f32_16x16x32_bf16 v[32:35], a[12:15], a[36:39], v[32:35]
    s_mov_b32 s46, s47
    v_mfma_f32_16x16x32_bf16 v[36:39], a[12:15], a[32:35], v[36:39]
    s_mul_i32 s68, s46, 576
    v_mfma_f32_16x16x32_bf16 v[40:43], a[124:127], a[0:3], v[40:43]
    s_add_u32 s45, s45, s68
    v_mfma_f32_16x16x32_bf16 v[44:47], a[124:127], a[108:111], v[44:47]
    s_add_u32 s45, s45, 36864
    v_mfma_f32_16x16x32_bf16 v[48:51], a[124:127], a[96:99], v[48:51]
    v_add_u32 v110, s45, v3
    v_mfma_f32_16x16x32_bf16 v[52:55], a[124:127], a[20:23], v[52:55]
    s_lshl_b32 s45, s46, 10
    v_mfma_f32_16x16x32_bf16 v[56:59], a[124:127], a[24:27], v[56:59]
    v_add_u32 v108, s45, v90
    v_mfma_f32_16x16x32_bf16 v[60:63], a[124:127], a[28:31], v[60:63]
    s_lshl_b32 s45, s46, 9
    v_mfma_f32_16x16x32_bf16 v[64:67], a[124:127], a[36:39], v[64:67]
    s_add_u32 s45, s45, 32768
    v_mfma_f32_16x16x32_bf16 v[68:71], a[124:127], a[32:35], v[68:71]
    v_lshl_add_u32 v109, v88, 3, s45
    s_waitcnt lgkmcnt(10)
    v_mfma_f32_16x16x32_bf16 v[72:75], a[16:19], a[76:79], v[72:75]
    s_lshl_b32 s45, s69, 13
    v_mfma_f32_16x16x32_bf16 v[76:79], a[16:19], a[104:107], v[76:79]
    s_lshl3_add_u32 s45, s47, s45
    s_waitcnt lgkmcnt(8)
    v_mfma_f32_16x16x32_bf16 v[80:83], a[48:51], a[76:79], v[80:83]
    v_add_u32 v107, s45, v90
    v_mfma_f32_16x16x32_bf16 v[84:87], a[48:51], a[104:107], v[84:87]
    s_and_b32 s69, s69, 1
    s_add_u32 m0, s29, 73728
    s_add_u32 s30, s29, 184320
    s_mov_b32 exec_hi, 0
    buffer_load_dwordx4 v89, s[16:19], s30 offen lds
    s_mov_b32 exec_hi, -1
    buffer_load_dwordx4 v89, s[16:19], s30 offen offset:512 lds
    buffer_load_dwordx4 v89, s[16:19], s30 offen offset:1536 lds
    buffer_load_dwordx4 v89, s[16:19], s30 offen offset:2560 lds
    buffer_load_dwordx4 v89, s[16:19], s30 offen offset:3584 lds
    s_lshl2_add_u32 s30, s70, s44
    s_mul_i32 s30, s30, 12
    v_add_u32 v6, s30, v88
    v_mul_u32_u24 v7, 3641, v6
    v_lshrrev_b32 v7, 20, v7
    v_mul_u32_u24 v7, 46080, v7
    v_lshl_add_u32 v6, v6, 7, v7
    s_mov_b32 s30, 36864
    s_mov_b64 exec, 4095
    buffer_load_dword v5, v6, s[16:19], s30 offen
    s_mov_b64 exec, -1
    s_add_u32 m0, s43, 18432
    s_movk_i32 s30, 128
    buffer_load_dwordx4 v104, s[12:15], s30 offen lds
    s_waitcnt vmcnt(7) lgkmcnt(0)
    s_barrier
    v_mfma_f32_16x16x32_bf16 v[8:11], a[52:55], a[8:11], v[8:11]
    ds_read_b64_tr_b16 a[112:113], v91 offset:36864
    v_mfma_f32_16x16x32_bf16 v[12:15], a[52:55], a[0:3], v[12:15]
    ds_read_b64_tr_b16 a[114:115], v91 offset:39168
    v_mfma_f32_16x16x32_bf16 v[16:19], a[52:55], a[108:111], v[16:19]
    ds_read_b128 a[116:119], v99 offset:9472
    v_mfma_f32_16x16x32_bf16 v[20:23], a[52:55], a[96:99], v[20:23]
    ds_read_b128 a[44:47], v99 offset:9600
    v_mfma_f32_16x16x32_bf16 v[24:27], a[52:55], a[20:23], v[24:27]
    ds_read_b128 a[56:59], v99 offset:9728
    v_mfma_f32_16x16x32_bf16 v[28:31], a[52:55], a[24:27], v[28:31]
    ds_read_b128 a[60:63], v99 offset:9856
    v_mfma_f32_16x16x32_bf16 v[32:35], a[52:55], a[28:31], v[32:35]
    ds_read_b128 a[80:83], v99 offset:10016
    v_mfma_f32_16x16x32_bf16 v[36:39], a[52:55], a[36:39], v[36:39]
    ds_read_b128 a[64:67], v99 offset:10144
    v_mfma_f32_16x16x32_bf16 v[40:43], a[88:91], a[8:11], v[40:43]
    ds_read_b128 a[68:71], v99 offset:10272
    v_mfma_f32_16x16x32_bf16 v[44:47], a[88:91], a[0:3], v[44:47]
    ds_read_b128 a[40:43], v99 offset:10400
    v_mfma_f32_16x16x32_bf16 v[48:51], a[88:91], a[108:111], v[48:51]
    ds_read_b64_tr_b16 a[72:73], v92 offset:36864
    v_mfma_f32_16x16x32_bf16 v[52:55], a[88:91], a[96:99], v[52:55]
    ds_read_b64_tr_b16 a[74:75], v92 offset:39168
    v_mfma_f32_16x16x32_bf16 v[56:59], a[88:91], a[20:23], v[56:59]
    ds_read_b64_tr_b16 a[4:5], v93 offset:36864
    v_mfma_f32_16x16x32_bf16 v[60:63], a[88:91], a[24:27], v[60:63]
    ds_read_b64_tr_b16 a[6:7], v93 offset:39168
    v_mfma_f32_16x16x32_bf16 v[64:67], a[88:91], a[28:31], v[64:67]
    ds_read_b128 a[100:103], v102 offset:8960
    v_mfma_f32_16x16x32_bf16 v[68:71], a[88:91], a[36:39], v[68:71]
    s_waitcnt lgkmcnt(8)
    ds_read_b128 a[12:15], v102 offset:9088
    v_mfma_f32_16x16x32_bf16 v[72:75], a[84:87], a[120:123], v[72:75]
    ds_read_b64_tr_b16 a[124:125], v94 offset:36864
    v_mfma_f32_16x16x32_bf16 v[76:79], a[84:87], a[76:79], v[76:79]
    ds_read_b64_tr_b16 a[126:127], v94 offset:39168
    v_mfma_f32_16x16x32_bf16 v[80:83], a[92:95], a[120:123], v[80:83]
    ds_read_b64_tr_b16 a[32:33], v95 offset:0
    v_mfma_f32_16x16x32_bf16 v[84:87], a[92:95], a[76:79], v[84:87]
    ds_read_b64_tr_b16 a[34:35], v95 offset:2304
    v_mfma_f32_16x16x32_bf16 v[8:11], a[112:115], a[116:119], v[8:11]
    ds_read_b64_tr_b16 a[16:17], v96 offset:0
    v_mfma_f32_16x16x32_bf16 v[12:15], a[112:115], a[44:47], v[12:15]
    ds_read_b64_tr_b16 a[18:19], v96 offset:2304
    v_mfma_f32_16x16x32_bf16 v[16:19], a[112:115], a[56:59], v[16:19]
    s_waitcnt lgkmcnt(8)
    ds_read_b64_tr_b16 a[48:49], v97 offset:0
    v_mfma_f32_16x16x32_bf16 v[20:23], a[112:115], a[60:63], v[20:23]
    ds_read_b64_tr_b16 a[50:51], v97 offset:2304
    v_mfma_f32_16x16x32_bf16 v[24:27], a[112:115], a[80:83], v[24:27]
    ds_read_b64_tr_b16 a[104:105], v98 offset:0
    v_mfma_f32_16x16x32_bf16 v[28:31], a[112:115], a[64:67], v[28:31]
    ds_read_b64_tr_b16 a[106:107], v98 offset:2304
    v_mfma_f32_16x16x32_bf16 v[32:35], a[112:115], a[68:71], v[32:35]
    ds_read_b128 a[52:55], v99 offset:9344
    v_mfma_f32_16x16x32_bf16 v[36:39], a[112:115], a[40:43], v[36:39]
    ds_read_b128 a[8:11], v101 offset:9088
    v_mfma_f32_16x16x32_bf16 v[40:43], a[72:75], a[116:119], v[40:43]
    ds_read_b128 a[0:3], v99 offset:9216
    v_mfma_f32_16x16x32_bf16 v[44:47], a[72:75], a[44:47], v[44:47]
    s_waitcnt lgkmcnt(8)
    ds_read_b128 a[108:111], v101 offset:8960
    v_mfma_f32_16x16x32_bf16 v[48:51], a[72:75], a[56:59], v[48:51]
    ds_read_b128 a[96:99], v99 offset:9088
    v_mfma_f32_16x16x32_bf16 v[52:55], a[72:75], a[60:63], v[52:55]
    s_add_u32 s45, s68, 37120
    v_mfma_f32_16x16x32_bf16 v[56:59], a[72:75], a[80:83], v[56:59]
    v_add_u32 v111, s45, v3
    v_mfma_f32_16x16x32_bf16 v[60:63], a[72:75], a[64:67], v[60:63]
    v_xor_b32 v112, 1024, v108
    v_mfma_f32_16x16x32_bf16 v[64:67], a[72:75], a[68:71], v[64:67]
    v_xor_b32 v113, 512, v109
    v_mfma_f32_16x16x32_bf16 v[68:71], a[72:75], a[40:43], v[68:71]
    s_mul_i32 s45, s47, -1152
    v_mfma_f32_16x16x32_bf16 v[72:75], a[4:7], a[100:103], v[72:75]
    ds_read_b128 a[20:23], v100 offset:9088
    v_mfma_f32_16x16x32_bf16 v[76:79], a[4:7], a[12:15], v[76:79]
    s_add_u32 s45, s45, 576
    v_mfma_f32_16x16x32_bf16 v[80:83], a[124:127], a[100:103], v[80:83]
    v_add_u32 v114, s45, v110
    v_mfma_f32_16x16x32_bf16 v[84:87], a[124:127], a[12:15], v[84:87]
    s_lshl_b32 s45, s44, 10
    s_add_u32 m0, s29, 0
    s_add_u32 s30, s29, 350208
    s_mov_b32 exec_hi, 0
    buffer_load_dwordx4 v89, s[16:19], s30 offen lds
    s_mov_b32 exec_hi, -1
    buffer_load_dwordx4 v89, s[16:19], s30 offen offset:512 lds
    buffer_load_dwordx4 v89, s[16:19], s30 offen offset:1536 lds
    buffer_load_dwordx4 v89, s[16:19], s30 offen offset:2560 lds
    buffer_load_dwordx4 v89, s[16:19], s30 offen offset:3584 lds
    s_waitcnt vmcnt(7) lgkmcnt(6)
    s_barrier
    s_waitcnt lgkmcnt(5)
    v_mfma_f32_16x16x32_bf16 v[8:11], a[32:35], a[52:55], v[8:11]
    ds_read_b64_tr_b16 a[24:25], v95 offset:18432
    v_mfma_f32_16x16x32_bf16 v[12:15], a[32:35], a[116:119], v[12:15]
    ds_read_b64_tr_b16 a[26:27], v95 offset:20736
    v_mfma_f32_16x16x32_bf16 v[16:19], a[32:35], a[44:47], v[16:19]
    ds_read_b64_tr_b16 a[28:29], v96 offset:18432
    v_mfma_f32_16x16x32_bf16 v[20:23], a[32:35], a[56:59], v[20:23]
    ds_read_b64_tr_b16 a[30:31], v96 offset:20736
    v_mfma_f32_16x16x32_bf16 v[24:27], a[32:35], a[60:63], v[24:27]
    ds_read_b64_tr_b16 a[88:89], v97 offset:18432
    v_mfma_f32_16x16x32_bf16 v[28:31], a[32:35], a[80:83], v[28:31]
    ds_read_b64_tr_b16 a[90:91], v97 offset:20736
    v_mfma_f32_16x16x32_bf16 v[32:35], a[32:35], a[64:67], v[32:35]
    ds_read_b64_tr_b16 a[36:37], v98 offset:18432
    v_mfma_f32_16x16x32_bf16 v[36:39], a[32:35], a[68:71], v[36:39]
    ds_read_b64_tr_b16 a[38:39], v98 offset:20736
    v_mfma_f32_16x16x32_bf16 v[40:43], a[16:19], a[52:55], v[40:43]
    ds_read_b64_tr_b16 a[84:85], v95 offset:36864
    v_mfma_f32_16x16x32_bf16 v[44:47], a[16:19], a[116:119], v[44:47]
    ds_read_b64_tr_b16 a[86:87], v95 offset:39168
    v_mfma_f32_16x16x32_bf16 v[48:51], a[16:19], a[44:47], v[48:51]
    s_waitcnt lgkmcnt(8)
    ds_read_b64_tr_b16 a[120:121], v96 offset:36864
    v_mfma_f32_16x16x32_bf16 v[52:55], a[16:19], a[56:59], v[52:55]
    ds_read_b64_tr_b16 a[122:123], v96 offset:39168
    v_mfma_f32_16x16x32_bf16 v[56:59], a[16:19], a[60:63], v[56:59]
    ds_read_b64_tr_b16 a[92:93], v97 offset:36864
    v_mfma_f32_16x16x32_bf16 v[60:63], a[16:19], a[80:83], v[60:63]
    ds_read_b64_tr_b16 a[94:95], v97 offset:39168
    v_mfma_f32_16x16x32_bf16 v[64:67], a[16:19], a[64:67], v[64:67]
    ds_read_b64_tr_b16 a[76:77], v98 offset:36864
    v_mfma_f32_16x16x32_bf16 v[68:71], a[16:19], a[68:71], v[68:71]
    ds_read_b64_tr_b16 a[78:79], v98 offset:39168
    v_mfma_f32_16x16x32_bf16 v[72:75], a[48:51], a[8:11], v[72:75]
    ds_read_b128 a[112:115], v99 offset:8960
    v_mfma_f32_16x16x32_bf16 v[76:79], a[48:51], a[100:103], v[76:79]
    s_waitcnt lgkmcnt(8)
    ds_read_b128 a[72:75], v100 offset:8960
    v_mfma_f32_16x16x32_bf16 v[80:83], a[104:107], a[8:11], v[80:83]
    s_add_u32 s45, s45, 32768
    v_mfma_f32_16x16x32_bf16 v[84:87], a[104:107], a[100:103], v[84:87]
    v_lshl_add_u32 v103, v88, 3, s45
    v_mfma_f32_16x16x32_bf16 v[8:11], a[24:27], a[0:3], v[8:11]
    v_mfma_f32_16x16x32_bf16 v[12:15], a[24:27], a[52:55], v[12:15]
    v_mfma_f32_16x16x32_bf16 v[16:19], a[24:27], a[116:119], v[16:19]
    v_mfma_f32_16x16x32_bf16 v[20:23], a[24:27], a[44:47], v[20:23]
    v_mfma_f32_16x16x32_bf16 v[24:27], a[24:27], a[56:59], v[24:27]
    v_mfma_f32_16x16x32_bf16 v[28:31], a[24:27], a[60:63], v[28:31]
    v_mfma_f32_16x16x32_bf16 v[32:35], a[24:27], a[80:83], v[32:35]
    v_mfma_f32_16x16x32_bf16 v[36:39], a[24:27], a[64:67], v[36:39]
    v_mfma_f32_16x16x32_bf16 v[40:43], a[28:31], a[0:3], v[40:43]
    v_mfma_f32_16x16x32_bf16 v[44:47], a[28:31], a[52:55], v[44:47]
    v_mfma_f32_16x16x32_bf16 v[48:51], a[28:31], a[116:119], v[48:51]
    v_mfma_f32_16x16x32_bf16 v[52:55], a[28:31], a[44:47], v[52:55]
    v_mfma_f32_16x16x32_bf16 v[56:59], a[28:31], a[56:59], v[56:59]
    v_mfma_f32_16x16x32_bf16 v[60:63], a[28:31], a[60:63], v[60:63]
    v_mfma_f32_16x16x32_bf16 v[64:67], a[28:31], a[80:83], v[64:67]
    v_mfma_f32_16x16x32_bf16 v[68:71], a[28:31], a[64:67], v[68:71]
    v_mfma_f32_16x16x32_bf16 v[72:75], a[88:91], a[108:111], v[72:75]
    v_mfma_f32_16x16x32_bf16 v[76:79], a[88:91], a[8:11], v[76:79]
    v_mfma_f32_16x16x32_bf16 v[80:83], a[36:39], a[108:111], v[80:83]
    v_mfma_f32_16x16x32_bf16 v[84:87], a[36:39], a[8:11], v[84:87]
    s_add_u32 m0, s29, 36864
    s_add_u32 s30, s29, 119808
    s_mov_b32 exec_hi, 0
    buffer_load_dwordx4 v89, s[16:19], s30 offen lds
    s_mov_b32 exec_hi, -1
    buffer_load_dwordx4 v89, s[16:19], s30 offen offset:512 lds
    buffer_load_dwordx4 v89, s[16:19], s30 offen offset:1536 lds
    buffer_load_dwordx4 v89, s[16:19], s30 offen offset:2560 lds
    buffer_load_dwordx4 v89, s[16:19], s30 offen offset:3584 lds
    s_waitcnt vmcnt(5) lgkmcnt(2)
    s_barrier
    v_mfma_f32_16x16x32_bf16 v[8:11], a[84:87], a[96:99], v[8:11]
    ds_read_b64_tr_b16 a[40:41], v91 offset:0
    v_mfma_f32_16x16x32_bf16 v[12:15], a[84:87], a[0:3], v[12:15]
    ds_read_b64_tr_b16 a[42:43], v91 offset:2304
    v_mfma_f32_16x16x32_bf16 v[16:19], a[84:87], a[52:55], v[16:19]
    ds_read_b64_tr_b16 a[4:5], v92 offset:0
    v_mfma_f32_16x16x32_bf16 v[20:23], a[84:87], a[116:119], v[20:23]
    ds_read_b64_tr_b16 a[6:7], v92 offset:2304
    v_mfma_f32_16x16x32_bf16 v[24:27], a[84:87], a[44:47], v[24:27]
    ds_read_b64_tr_b16 a[124:125], v93 offset:0
    v_mfma_f32_16x16x32_bf16 v[28:31], a[84:87], a[56:59], v[28:31]
    ds_read_b64_tr_b16 a[126:127], v93 offset:2304
    v_mfma_f32_16x16x32_bf16 v[32:35], a[84:87], a[60:63], v[32:35]
    ds_read_b64_tr_b16 a[12:13], v94 offset:0
    v_mfma_f32_16x16x32_bf16 v[36:39], a[84:87], a[80:83], v[36:39]
    ds_read_b64_tr_b16 a[14:15], v94 offset:2304
    v_mfma_f32_16x16x32_bf16 v[40:43], a[120:123], a[96:99], v[40:43]
    ds_read_b64_tr_b16 a[32:33], v91 offset:18432
    v_mfma_f32_16x16x32_bf16 v[44:47], a[120:123], a[0:3], v[44:47]
    ds_read_b64_tr_b16 a[34:35], v91 offset:20736
    v_mfma_f32_16x16x32_bf16 v[48:51], a[120:123], a[52:55], v[48:51]
    ds_read_b64_tr_b16 a[16:17], v92 offset:18432
    v_mfma_f32_16x16x32_bf16 v[52:55], a[120:123], a[116:119], v[52:55]
    ds_read_b64_tr_b16 a[18:19], v92 offset:20736
    v_mfma_f32_16x16x32_bf16 v[56:59], a[120:123], a[44:47], v[56:59]
    ds_read_b64_tr_b16 a[68:69], v93 offset:18432
    v_mfma_f32_16x16x32_bf16 v[60:63], a[120:123], a[56:59], v[60:63]
    s_waitcnt lgkmcnt(8)
    ds_read_b64_tr_b16 a[70:71], v93 offset:20736
    v_mfma_f32_16x16x32_bf16 v[64:67], a[120:123], a[60:63], v[64:67]
    ds_read_b64_tr_b16 a[48:49], v94 offset:18432
    v_mfma_f32_16x16x32_bf16 v[68:71], a[120:123], a[80:83], v[68:71]
    ds_read_b64_tr_b16 a[50:51], v94 offset:20736
    v_mfma_f32_16x16x32_bf16 v[72:75], a[92:95], a[20:23], v[72:75]
    ds_read_b128 a[104:107], v99 offset:18944
    v_mfma_f32_16x16x32_bf16 v[76:79], a[92:95], a[108:111], v[76:79]
    ds_read_b128 a[100:103], v99 offset:19072
    v_mfma_f32_16x16x32_bf16 v[80:83], a[76:79], a[20:23], v[80:83]
    ds_read_b128 a[24:27], v99 offset:19200
    v_mfma_f32_16x16x32_bf16 v[84:87], a[76:79], a[108:111], v[84:87]
    ds_read_b128 a[28:31], v99 offset:19328
    v_mfma_f32_16x16x32_bf16 v[8:11], a[40:43], a[112:115], v[8:11]
    s_waitcnt lgkmcnt(8)
    ds_read_b128 a[64:67], v99 offset:19488
    v_mfma_f32_16x16x32_bf16 v[12:15], a[40:43], a[96:99], v[12:15]
    ds_read_b128 a[88:91], v99 offset:19616
    v_mfma_f32_16x16x32_bf16 v[16:19], a[40:43], a[0:3], v[16:19]
    ds_read_b128 a[36:39], v99 offset:19744
    v_mfma_f32_16x16x32_bf16 v[20:23], a[40:43], a[52:55], v[20:23]
    ds_read_b128 a[8:11], v99 offset:19872
    v_mfma_f32_16x16x32_bf16 v[24:27], a[40:43], a[116:119], v[24:27]
    ds_read_b128 a[84:87], v102 offset:18432
    v_mfma_f32_16x16x32_bf16 v[28:31], a[40:43], a[44:47], v[28:31]
    ds_read_b128 a[120:123], v102 offset:18560
    v_mfma_f32_16x16x32_bf16 v[32:35], a[40:43], a[56:59], v[32:35]
    ds_read_b128 a[80:83], v99 offset:18816
    v_mfma_f32_16x16x32_bf16 v[36:39], a[40:43], a[60:63], v[36:39]
    v_mfma_f32_16x16x32_bf16 v[40:43], a[4:7], a[112:115], v[40:43]
    v_mfma_f32_16x16x32_bf16 v[44:47], a[4:7], a[96:99], v[44:47]
    v_mfma_f32_16x16x32_bf16 v[48:51], a[4:7], a[0:3], v[48:51]
    v_mfma_f32_16x16x32_bf16 v[52:55], a[4:7], a[52:55], v[52:55]
    v_mfma_f32_16x16x32_bf16 v[56:59], a[4:7], a[116:119], v[56:59]
    s_waitcnt lgkmcnt(8)
    ds_read_b128 a[92:95], v101 offset:18560
    v_mfma_f32_16x16x32_bf16 v[60:63], a[4:7], a[44:47], v[60:63]
    ds_read_b128 a[76:79], v99 offset:18688
    v_mfma_f32_16x16x32_bf16 v[64:67], a[4:7], a[56:59], v[64:67]
    v_mfma_f32_16x16x32_bf16 v[68:71], a[4:7], a[60:63], v[68:71]
    v_mfma_f32_16x16x32_bf16 v[72:75], a[124:127], a[72:75], v[72:75]
    ds_read_b128 a[108:111], v101 offset:18432
    v_mfma_f32_16x16x32_bf16 v[76:79], a[124:127], a[20:23], v[76:79]
    v_mfma_f32_16x16x32_bf16 v[80:83], a[12:15], a[72:75], v[80:83]
    v_mfma_f32_16x16x32_bf16 v[84:87], a[12:15], a[20:23], v[84:87]
    s_mul_i32 s30, s3, 576
    s_add_u32 m0, s30, 152064
    s_add_u32 s30, s30, 36864
    s_mov_b32 exec_hi, 15
    buffer_load_dwordx4 v90, s[20:23], s30 offen lds
    s_mov_b32 exec_hi, -1
    s_add_u32 m0, s29, 73728
    s_add_u32 s30, s29, 285696
    s_mov_b32 exec_hi, 0
    buffer_load_dwordx4 v89, s[16:19], s30 offen lds
    s_mov_b32 exec_hi, -1
    buffer_load_dwordx4 v89, s[16:19], s30 offen offset:512 lds
    buffer_load_dwordx4 v89, s[16:19], s30 offen offset:1536 lds
    buffer_load_dwordx4 v89, s[16:19], s30 offen offset:2560 lds
    buffer_load_dwordx4 v89, s[16:19], s30 offen offset:3584 lds
    s_waitcnt vmcnt(6)
    s_barrier
    v_mfma_f32_16x16x32_bf16 v[8:11], a[32:35], a[104:107], v[8:11]
    ds_read_b64_tr_b16 a[40:41], v91 offset:36864
    v_mfma_f32_16x16x32_bf16 v[12:15], a[32:35], a[100:103], v[12:15]
    ds_read_b64_tr_b16 a[42:43], v91 offset:39168
    v_mfma_f32_16x16x32_bf16 v[16:19], a[32:35], a[24:27], v[16:19]
    ds_read_b64_tr_b16 a[112:113], v92 offset:36864
    s_waitcnt lgkmcnt(13)
    v_mfma_f32_16x16x32_bf16 v[20:23], a[32:35], a[28:31], v[20:23]
    ds_read_b64_tr_b16 a[114:115], v92 offset:39168
    s_waitcnt lgkmcnt(13)
    v_mfma_f32_16x16x32_bf16 v[24:27], a[32:35], a[64:67], v[24:27]
    ds_read_b64_tr_b16 a[96:97], v93 offset:36864
    s_waitcnt lgkmcnt(13)
    v_mfma_f32_16x16x32_bf16 v[28:31], a[32:35], a[88:91], v[28:31]
    ds_read_b64_tr_b16 a[98:99], v93 offset:39168
    s_waitcnt lgkmcnt(13)
    v_mfma_f32_16x16x32_bf16 v[32:35], a[32:35], a[36:39], v[32:35]
    ds_read_b64_tr_b16 a[0:1], v94 offset:36864
    s_waitcnt lgkmcnt(13)
    v_mfma_f32_16x16x32_bf16 v[36:39], a[32:35], a[8:11], v[36:39]
    ds_read_b64_tr_b16 a[2:3], v94 offset:39168
    v_mfma_f32_16x16x32_bf16 v[40:43], a[16:19], a[104:107], v[40:43]
    ds_read_b64_tr_b16 a[52:53], v95 offset:0
    v_mfma_f32_16x16x32_bf16 v[44:47], a[16:19], a[100:103], v[44:47]
    s_waitcnt lgkmcnt(8)
    ds_read_b64_tr_b16 a[54:55], v95 offset:2304
    v_mfma_f32_16x16x32_bf16 v[48:51], a[16:19], a[24:27], v[48:51]
    ds_read_b64_tr_b16 a[116:117], v96 offset:0
    v_mfma_f32_16x16x32_bf16 v[52:55], a[16:19], a[28:31], v[52:55]
    ds_read_b64_tr_b16 a[118:119], v96 offset:2304
    v_mfma_f32_16x16x32_bf16 v[56:59], a[16:19], a[64:67], v[56:59]
    ds_read_b64_tr_b16 a[44:45], v97 offset:0
    v_mfma_f32_16x16x32_bf16 v[60:63], a[16:19], a[88:91], v[60:63]
    ds_read_b64_tr_b16 a[46:47], v97 offset:2304
    v_mfma_f32_16x16x32_bf16 v[64:67], a[16:19], a[36:39], v[64:67]
    ds_read_b64_tr_b16 a[56:57], v98 offset:0
    v_mfma_f32_16x16x32_bf16 v[68:71], a[16:19], a[8:11], v[68:71]
    ds_read_b64_tr_b16 a[58:59], v98 offset:2304
    v_mfma_f32_16x16x32_bf16 v[72:75], a[68:71], a[84:87], v[72:75]
    s_waitcnt lgkmcnt(8)
    ds_read_b128 a[4:7], v99 offset:18560
    v_mfma_f32_16x16x32_bf16 v[76:79], a[68:71], a[120:123], v[76:79]
    ds_read_b128 a[60:63], v100 offset:18560
    v_mfma_f32_16x16x32_bf16 v[80:83], a[48:51], a[84:87], v[80:83]
    v_mfma_f32_16x16x32_bf16 v[84:87], a[48:51], a[120:123], v[84:87]
    v_mfma_f32_16x16x32_bf16 v[8:11], a[40:43], a[80:83], v[8:11]
    ds_read_b128 a[124:127], v99 offset:18432
    v_mfma_f32_16x16x32_bf16 v[12:15], a[40:43], a[104:107], v[12:15]
    v_mfma_f32_16x16x32_bf16 v[16:19], a[40:43], a[100:103], v[16:19]
    v_mfma_f32_16x16x32_bf16 v[20:23], a[40:43], a[24:27], v[20:23]
    v_mfma_f32_16x16x32_bf16 v[24:27], a[40:43], a[28:31], v[24:27]
    v_mfma_f32_16x16x32_bf16 v[28:31], a[40:43], a[64:67], v[28:31]
    v_mfma_f32_16x16x32_bf16 v[32:35], a[40:43], a[88:91], v[32:35]
    v_mfma_f32_16x16x32_bf16 v[36:39], a[40:43], a[36:39], v[36:39]
    v_mfma_f32_16x16x32_bf16 v[40:43], a[112:115], a[80:83], v[40:43]
    v_mfma_f32_16x16x32_bf16 v[44:47], a[112:115], a[104:107], v[44:47]
    s_add_u32 m0, s43, 27392
    s_movk_i32 s30, 192
    buffer_load_dwordx4 v104, s[12:15], s30 offen lds
    s_add_u32 m0, s29, 0
    s_add_u32 s30, s29, 55296
    s_mov_b32 exec_hi, 0
    buffer_load_dwordx4 v89, s[16:19], s30 offen lds
    s_mov_b32 exec_hi, -1
    buffer_load_dwordx4 v89, s[16:19], s30 offen offset:512 lds
    buffer_load_dwordx4 v89, s[16:19], s30 offen offset:1536 lds
    buffer_load_dwordx4 v89, s[16:19], s30 offen offset:2560 lds
    buffer_load_dwordx4 v89, s[16:19], s30 offen offset:3584 lds
    s_waitcnt vmcnt(6) lgkmcnt(3)
    s_barrier
    v_mfma_f32_16x16x32_bf16 v[48:51], a[112:115], a[100:103], v[48:51]
    ds_read_b64_tr_b16 a[72:73], v95 offset:18432
    v_mfma_f32_16x16x32_bf16 v[52:55], a[112:115], a[24:27], v[52:55]
    ds_read_b64_tr_b16 a[74:75], v95 offset:20736
    v_mfma_f32_16x16x32_bf16 v[56:59], a[112:115], a[28:31], v[56:59]
    ds_read_b64_tr_b16 a[12:13], v96 offset:18432
    v_mfma_f32_16x16x32_bf16 v[60:63], a[112:115], a[64:67], v[60:63]
    ds_read_b64_tr_b16 a[14:15], v96 offset:20736
    v_mfma_f32_16x16x32_bf16 v[64:67], a[112:115], a[88:91], v[64:67]
    ds_read_b64_tr_b16 a[20:21], v97 offset:18432
    v_mfma_f32_16x16x32_bf16 v[68:71], a[112:115], a[36:39], v[68:71]
    ds_read_b64_tr_b16 a[22:23], v97 offset:20736
    v_mfma_f32_16x16x32_bf16 v[72:75], a[96:99], a[92:95], v[72:75]
    ds_read_b64_tr_b16 a[32:33], v98 offset:18432
    v_mfma_f32_16x16x32_bf16 v[76:79], a[96:99], a[84:87], v[76:79]
    ds_read_b64_tr_b16 a[34:35], v98 offset:20736
    v_mfma_f32_16x16x32_bf16 v[80:83], a[0:3], a[92:95], v[80:83]
    ds_read_b64_tr_b16 a[16:17], v95 offset:36864
    v_mfma_f32_16x16x32_bf16 v[84:87], a[0:3], a[84:87], v[84:87]
    ds_read_b64_tr_b16 a[18:19], v95 offset:39168
    v_mfma_f32_16x16x32_bf16 v[8:11], a[52:55], a[76:79], v[8:11]
    ds_read_b64_tr_b16 a[8:9], v96 offset:36864
    v_mfma_f32_16x16x32_bf16 v[12:15], a[52:55], a[80:83], v[12:15]
    ds_read_b64_tr_b16 a[10:11], v96 offset:39168
    v_mfma_f32_16x16x32_bf16 v[16:19], a[52:55], a[104:107], v[16:19]
    s_waitcnt lgkmcnt(8)
    ds_read_b64_tr_b16 a[68:69], v97 offset:36864
    v_mfma_f32_16x16x32_bf16 v[20:23], a[52:55], a[100:103], v[20:23]
    ds_read_b64_tr_b16 a[70:71], v97 offset:39168
    v_mfma_f32_16x16x32_bf16 v[24:27], a[52:55], a[24:27], v[24:27]
    ds_read_b64_tr_b16 a[48:49], v98 offset:36864
    v_mfma_f32_16x16x32_bf16 v[28:31], a[52:55], a[28:31], v[28:31]
    ds_read_b64_tr_b16 a[50:51], v98 offset:39168
    v_mfma_f32_16x16x32_bf16 v[32:35], a[52:55], a[64:67], v[32:35]
    v_mfma_f32_16x16x32_bf16 v[36:39], a[52:55], a[88:91], v[36:39]
    v_mfma_f32_16x16x32_bf16 v[40:43], a[116:119], a[76:79], v[40:43]
    v_mfma_f32_16x16x32_bf16 v[44:47], a[116:119], a[80:83], v[44:47]
    v_mfma_f32_16x16x32_bf16 v[48:51], a[116:119], a[104:107], v[48:51]
    v_mfma_f32_16x16x32_bf16 v[52:55], a[116:119], a[100:103], v[52:55]
    v_mfma_f32_16x16x32_bf16 v[56:59], a[116:119], a[24:27], v[56:59]
    v_mfma_f32_16x16x32_bf16 v[60:63], a[116:119], a[28:31], v[60:63]
    v_mfma_f32_16x16x32_bf16 v[64:67], a[116:119], a[64:67], v[64:67]
    v_mfma_f32_16x16x32_bf16 v[68:71], a[116:119], a[88:91], v[68:71]
    ds_read_b128 a[120:123], v100 offset:18432
    v_mfma_f32_16x16x32_bf16 v[72:75], a[44:47], a[108:111], v[72:75]
    v_mfma_f32_16x16x32_bf16 v[76:79], a[44:47], a[92:95], v[76:79]
    v_mfma_f32_16x16x32_bf16 v[80:83], a[56:59], a[108:111], v[80:83]
    v_mfma_f32_16x16x32_bf16 v[84:87], a[56:59], a[92:95], v[84:87]
    s_add_u32 m0, s29, 55296
    s_add_u32 s30, s29, 304128
    s_mov_b32 exec_hi, 0
    buffer_load_dwordx4 v89, s[16:19], s30 offen lds
    s_mov_b32 exec_hi, -1
    buffer_load_dwordx4 v89, s[16:19], s30 offen offset:512 lds
    buffer_load_dwordx4 v89, s[16:19], s30 offen offset:1536 lds
    buffer_load_dwordx4 v89, s[16:19], s30 offen offset:2560 lds
    buffer_load_dwordx4 v89, s[16:19], s30 offen offset:3584 lds
    s_waitcnt vmcnt(5) lgkmcnt(1)
    s_barrier
    v_mfma_f32_16x16x32_bf16 v[8:11], a[72:75], a[4:7], v[8:11]
    ds_read_b64_tr_b16 a[40:41], v93 offset:0
    v_mfma_f32_16x16x32_bf16 v[12:15], a[72:75], a[76:79], v[12:15]
    ds_read_b64_tr_b16 a[42:43], v93 offset:2304
    v_mfma_f32_16x16x32_bf16 v[16:19], a[72:75], a[80:83], v[16:19]
    ds_read_b64_tr_b16 a[112:113], v93 offset:18432
    v_mfma_f32_16x16x32_bf16 v[20:23], a[72:75], a[104:107], v[20:23]
    ds_read_b64_tr_b16 a[114:115], v93 offset:20736
    v_mfma_f32_16x16x32_bf16 v[24:27], a[72:75], a[100:103], v[24:27]
    ds_read_b64_tr_b16 a[36:37], v94 offset:0
    v_mfma_f32_16x16x32_bf16 v[28:31], a[72:75], a[24:27], v[28:31]
    ds_read_b64_tr_b16 a[38:39], v94 offset:2304
    v_mfma_f32_16x16x32_bf16 v[32:35], a[72:75], a[28:31], v[32:35]
    ds_read_b64_tr_b16 a[96:97], v94 offset:18432
    v_mfma_f32_16x16x32_bf16 v[36:39], a[72:75], a[64:67], v[36:39]
    ds_read_b64_tr_b16 a[98:99], v94 offset:20736
    v_mfma_f32_16x16x32_bf16 v[40:43], a[12:15], a[4:7], v[40:43]
    ds_read_b64_tr_b16 a[0:1], v91 offset:0
    v_mfma_f32_16x16x32_bf16 v[44:47], a[12:15], a[76:79], v[44:47]
    ds_read_b64_tr_b16 a[2:3], v91 offset:2304
    v_mfma_f32_16x16x32_bf16 v[48:51], a[12:15], a[80:83], v[48:51]
    ds_read_b64_tr_b16 a[84:85], v91 offset:18432
    v_mfma_f32_16x16x32_bf16 v[52:55], a[12:15], a[104:107], v[52:55]
    ds_read_b64_tr_b16 a[86:87], v91 offset:20736
    v_mfma_f32_16x16x32_bf16 v[56:59], a[12:15], a[100:103], v[56:59]
    ds_read_b64_tr_b16 a[52:53], v92 offset:0
    v_mfma_f32_16x16x32_bf16 v[60:63], a[12:15], a[24:27], v[60:63]
    ds_read_b64_tr_b16 a[54:55], v92 offset:2304
    v_mfma_f32_16x16x32_bf16 v[64:67], a[12:15], a[28:31], v[64:67]
    s_waitcnt lgkmcnt(8)
    ds_read_b64_tr_b16 a[116:117], v92 offset:18432
    v_mfma_f32_16x16x32_bf16 v[68:71], a[12:15], a[64:67], v[68:71]
    ds_read_b64_tr_b16 a[118:119], v92 offset:20736
    v_mfma_f32_16x16x32_bf16 v[72:75], a[20:23], a[60:63], v[72:75]
    ds_read_b128 a[88:91], v102 offset:27392
    v_mfma_f32_16x16x32_bf16 v[76:79], a[20:23], a[108:111], v[76:79]
    ds_read_b128 a[44:47], v101 offset:27520
    v_mfma_f32_16x16x32_bf16 v[80:83], a[32:35], a[60:63], v[80:83]
    ds_read_b128 a[56:59], v101 offset:27392
    v_mfma_f32_16x16x32_bf16 v[84:87], a[32:35], a[108:111], v[84:87]
    ds_read_b128 a[92:95], v100 offset:27520
    v_mfma_f32_16x16x32_bf16 v[8:11], a[16:19], a[124:127], v[8:11]
    ds_read_b128 a[72:75], v100 offset:27392
    v_mfma_f32_16x16x32_bf16 v[12:15], a[16:19], a[4:7], v[12:15]
    v_mfma_f32_16x16x32_bf16 v[16:19], a[16:19], a[76:79], v[16:19]
    v_mfma_f32_16x16x32_bf16 v[20:23], a[16:19], a[80:83], v[20:23]
    v_mfma_f32_16x16x32_bf16 v[24:27], a[16:19], a[104:107], v[24:27]
    v_mfma_f32_16x16x32_bf16 v[28:31], a[16:19], a[100:103], v[28:31]
    s_add_u32 m0, s29, 110592
    s_add_u32 s30, s29, 0
    s_mov_b32 exec_hi, 0
    buffer_load_dwordx4 v90, s[20:23], s30 offen lds
    s_mov_b32 exec_hi, -1
    buffer_load_dwordx4 v90, s[20:23], s30 offen offset:512 lds
    buffer_load_dwordx4 v90, s[20:23], s30 offen offset:1536 lds
    buffer_load_dwordx4 v90, s[20:23], s30 offen offset:2560 lds
    buffer_load_dwordx4 v90, s[20:23], s30 offen offset:3584 lds
    s_waitcnt vmcnt(5) lgkmcnt(5)
    s_barrier
    v_mfma_f32_16x16x32_bf16 v[32:35], a[16:19], a[24:27], v[32:35]
    ds_read_b64_tr_b16 a[12:13], v93 offset:36864
    v_mfma_f32_16x16x32_bf16 v[36:39], a[16:19], a[28:31], v[36:39]
    ds_read_b64_tr_b16 a[14:15], v93 offset:39168
    v_mfma_f32_16x16x32_bf16 v[40:43], a[8:11], a[124:127], v[40:43]
    ds_read_b64_tr_b16 a[64:65], v97 offset:0
    v_mfma_f32_16x16x32_bf16 v[44:47], a[8:11], a[4:7], v[44:47]
    ds_read_b64_tr_b16 a[66:67], v97 offset:2304
    v_mfma_f32_16x16x32_bf16 v[48:51], a[8:11], a[76:79], v[48:51]
    ds_read_b64_tr_b16 a[20:21], v97 offset:18432
    v_mfma_f32_16x16x32_bf16 v[52:55], a[8:11], a[80:83], v[52:55]
    ds_read_b64_tr_b16 a[22:23], v97 offset:20736
    v_mfma_f32_16x16x32_bf16 v[56:59], a[8:11], a[104:107], v[56:59]
    ds_read_b64_tr_b16 a[32:33], v94 offset:36864
    v_mfma_f32_16x16x32_bf16 v[60:63], a[8:11], a[100:103], v[60:63]
    ds_read_b64_tr_b16 a[34:35], v94 offset:39168
    v_mfma_f32_16x16x32_bf16 v[64:67], a[8:11], a[24:27], v[64:67]
    ds_read_b64_tr_b16 a[108:109], v98 offset:0
    v_mfma_f32_16x16x32_bf16 v[68:71], a[8:11], a[28:31], v[68:71]
    ds_read_b64_tr_b16 a[110:111], v98 offset:2304
    v_mfma_f32_16x16x32_bf16 v[72:75], a[68:71], a[120:123], v[72:75]
    s_waitcnt lgkmcnt(8)
    ds_read_b64_tr_b16 a[16:17], v98 offset:18432
    v_mfma_f32_16x16x32_bf16 v[76:79], a[68:71], a[60:63], v[76:79]
    ds_read_b64_tr_b16 a[18:19], v98 offset:20736
    v_mfma_f32_16x16x32_bf16 v[80:83], a[48:51], a[120:123], v[80:83]
    ds_read_b128 a[124:127], v102 offset:27520
    v_mfma_f32_16x16x32_bf16 v[84:87], a[48:51], a[60:63], v[84:87]
    ds_read_b128 a[4:7], v99 offset:27904
    v_mfma_f32_16x16x32_bf16 v[72:75], a[40:43], a[88:91], v[72:75]
    ds_read_b128 a[76:79], v99 offset:27776
    v_mfma_f32_16x16x32_bf16 v[72:75], a[112:115], a[44:47], v[72:75]
    ds_read_b64_tr_b16 a[80:81], v91 offset:36864
    v_mfma_f32_16x16x32_bf16 v[72:75], a[12:15], a[56:59], v[72:75]
    ds_read_b64_tr_b16 a[82:83], v91 offset:39168
    s_waitcnt lgkmcnt(13)
    v_mfma_f32_16x16x32_bf16 v[72:75], a[64:67], a[92:95], v[72:75]
    ds_read_b128 a[104:107], v99 offset:27648
    s_waitcnt lgkmcnt(12)
    v_mfma_f32_16x16x32_bf16 v[72:75], a[20:23], a[72:75], v[72:75]
    ds_read_b64_tr_b16 a[100:101], v95 offset:0
    v_mfma_f32_16x16x32_bf16 v[80:83], a[36:39], a[88:91], v[80:83]
    ds_read_b64_tr_b16 a[102:103], v95 offset:2304
    v_mfma_f32_16x16x32_bf16 v[80:83], a[96:99], a[44:47], v[80:83]
    ds_read_b128 a[24:27], v99 offset:27520
    s_waitcnt lgkmcnt(13)
    v_mfma_f32_16x16x32_bf16 v[80:83], a[32:35], a[56:59], v[80:83]
    ds_read_b64_tr_b16 a[8:9], v95 offset:18432
    s_waitcnt lgkmcnt(12)
    v_mfma_f32_16x16x32_bf16 v[80:83], a[108:111], a[92:95], v[80:83]
    ds_read_b64_tr_b16 a[10:11], v95 offset:20736
    s_waitcnt lgkmcnt(11)
    v_mfma_f32_16x16x32_bf16 v[80:83], a[16:19], a[72:75], v[80:83]
    ds_read_b128 a[28:31], v99 offset:27392
    s_waitcnt lgkmcnt(11)
    v_mfma_f32_16x16x32_bf16 v[76:79], a[40:43], a[124:127], v[76:79]
    ds_read_b64_tr_b16 a[68:69], v92 offset:36864
    v_mfma_f32_16x16x32_bf16 v[76:79], a[112:115], a[88:91], v[76:79]
    ds_read_b64_tr_b16 a[70:71], v92 offset:39168
    v_mfma_f32_16x16x32_bf16 v[76:79], a[12:15], a[44:47], v[76:79]
    ds_read_b64_tr_b16 a[120:121], v96 offset:0
    v_mfma_f32_16x16x32_bf16 v[76:79], a[64:67], a[56:59], v[76:79]
    ds_read_b64_tr_b16 a[122:123], v96 offset:2304
    v_mfma_f32_16x16x32_bf16 v[76:79], a[20:23], a[92:95], v[76:79]
    s_waitcnt lgkmcnt(8)
    ds_read_b64_tr_b16 a[48:49], v96 offset:18432
    v_mfma_f32_16x16x32_bf16 v[84:87], a[36:39], a[124:127], v[84:87]
    ds_read_b64_tr_b16 a[50:51], v96 offset:20736
    v_mfma_f32_16x16x32_bf16 v[84:87], a[96:99], a[88:91], v[84:87]
    ds_read_b128 a[60:63], v99 offset:28032
    v_mfma_f32_16x16x32_bf16 v[84:87], a[32:35], a[44:47], v[84:87]
    ds_read_b128 a[72:75], v99 offset:28160
    v_mfma_f32_16x16x32_bf16 v[84:87], a[108:111], a[56:59], v[84:87]
    ds_read_b128 a[40:43], v99 offset:28288
    v_mfma_f32_16x16x32_bf16 v[84:87], a[16:19], a[92:95], v[84:87]
    ds_read_b128 a[112:115], v99 offset:28448
    v_mfma_f32_16x16x32_bf16 v[8:11], a[0:3], a[4:7], v[8:11]
    ds_read_b128 a[12:15], v99 offset:28576
    v_mfma_f32_16x16x32_bf16 v[8:11], a[84:87], a[76:79], v[8:11]
    s_waitcnt lgkmcnt(8)
    ds_read_b128 a[64:67], v99 offset:28704
    v_mfma_f32_16x16x32_bf16 v[8:11], a[80:83], a[104:107], v[8:11]
    v_mfma_f32_16x16x32_bf16 v[8:11], a[100:103], a[24:27], v[8:11]
    v_mul_f32 v72, s52, v72
    v_mul_f32 v73, s52, v73
    v_mfma_f32_16x16x32_bf16 v[8:11], a[8:11], a[28:31], v[8:11]
    v_mul_f32 v74, s52, v74
    v_mul_f32 v75, s52, v75
    v_mfma_f32_16x16x32_bf16 v[40:43], a[52:55], a[4:7], v[40:43]
    v_mul_f32 v76, s52, v76
    v_mul_f32 v77, s52, v77
    v_mfma_f32_16x16x32_bf16 v[40:43], a[116:119], a[76:79], v[40:43]
    v_mul_f32 v78, s52, v78
    v_mul_f32 v79, s52, v79
    v_mfma_f32_16x16x32_bf16 v[40:43], a[68:71], a[104:107], v[40:43]
    v_mul_f32 v80, s32, v80
    v_mul_f32 v81, s32, v81
    s_waitcnt lgkmcnt(8)
    v_mfma_f32_16x16x32_bf16 v[40:43], a[120:123], a[24:27], v[40:43]
    v_mul_f32 v82, s32, v82
    v_mul_f32 v83, s32, v83
    s_waitcnt lgkmcnt(6)
    v_mfma_f32_16x16x32_bf16 v[40:43], a[48:51], a[28:31], v[40:43]
    v_mul_f32 v84, s32, v84
    v_mul_f32 v85, s32, v85
    s_waitcnt lgkmcnt(5)
    v_mfma_f32_16x16x32_bf16 v[12:15], a[0:3], a[60:63], v[12:15]
    v_mul_f32 v86, s32, v86
    v_mul_f32 v87, s32, v87
    ds_read_b128 a[20:23], v99 offset:28832
    v_mfma_f32_16x16x32_bf16 v[12:15], a[84:87], a[4:7], v[12:15]
    v_exp_f32 v72, v72
    v_mfma_f32_16x16x32_bf16 v[12:15], a[80:83], a[76:79], v[12:15]
    v_exp_f32 v73, v73
    v_mfma_f32_16x16x32_bf16 v[12:15], a[100:103], a[104:107], v[12:15]
    v_exp_f32 v74, v74
    v_mfma_f32_16x16x32_bf16 v[12:15], a[8:11], a[24:27], v[12:15]
    v_exp_f32 v75, v75
    v_mfma_f32_16x16x32_bf16 v[44:47], a[52:55], a[60:63], v[44:47]
    v_exp_f32 v76, v76
    v_mfma_f32_16x16x32_bf16 v[44:47], a[116:119], a[4:7], v[44:47]
    v_exp_f32 v77, v77
    v_mfma_f32_16x16x32_bf16 v[44:47], a[68:71], a[76:79], v[44:47]
    v_exp_f32 v78, v78
    v_mfma_f32_16x16x32_bf16 v[44:47], a[120:123], a[104:107], v[44:47]
    v_exp_f32 v79, v79
    v_mfma_f32_16x16x32_bf16 v[44:47], a[48:51], a[24:27], v[44:47]
    v_exp_f32 v80, v80
    s_waitcnt lgkmcnt(5)
    v_mfma_f32_16x16x32_bf16 v[16:19], a[0:3], a[72:75], v[16:19]
    v_exp_f32 v81, v81
    v_mfma_f32_16x16x32_bf16 v[16:19], a[84:87], a[60:63], v[16:19]
    v_exp_f32 v82, v82
    v_mfma_f32_16x16x32_bf16 v[16:19], a[80:83], a[4:7], v[16:19]
    v_exp_f32 v83, v83
    v_mfma_f32_16x16x32_bf16 v[16:19], a[100:103], a[76:79], v[16:19]
    v_exp_f32 v84, v84
    v_mfma_f32_16x16x32_bf16 v[16:19], a[8:11], a[104:107], v[16:19]
    v_exp_f32 v85, v85
    v_mfma_f32_16x16x32_bf16 v[48:51], a[52:55], a[72:75], v[48:51]
    v_exp_f32 v86, v86
    v_mfma_f32_16x16x32_bf16 v[48:51], a[116:119], a[60:63], v[48:51]
    v_exp_f32 v87, v87
    v_mfma_f32_16x16x32_bf16 v[48:51], a[68:71], a[4:7], v[48:51]
    v_fma_f32 v72, v72, s34, s34 clamp
    v_fma_f32 v73, v73, s34, s34 clamp
    v_mfma_f32_16x16x32_bf16 v[48:51], a[120:123], a[76:79], v[48:51]
    v_fma_f32 v74, v74, s34, s34 clamp
    v_fma_f32 v75, v75, s34, s34 clamp
    v_mfma_f32_16x16x32_bf16 v[48:51], a[48:51], a[104:107], v[48:51]
    v_fma_f32 v76, v76, s34, s34 clamp
    v_fma_f32 v77, v77, s34, s34 clamp
    s_waitcnt lgkmcnt(4)
    v_mfma_f32_16x16x32_bf16 v[20:23], a[0:3], a[40:43], v[20:23]
    v_fma_f32 v78, v78, s34, s34 clamp
    v_fma_f32 v79, v79, s34, s34 clamp
    s_waitcnt vmcnt(0)
    s_barrier
    v_mfma_f32_16x16x32_bf16 v[20:23], a[84:87], a[72:75], v[20:23]
    v_fma_f32 v80, v72, v80, v72
    v_fma_f32 v81, v73, v81, v73
    ds_read_b64_tr_b16 a[36:37], v105 offset:18432
    v_mfma_f32_16x16x32_bf16 v[20:23], a[80:83], a[60:63], v[20:23]
    v_fma_f32 v82, v74, v82, v74
    v_fma_f32 v83, v75, v83, v75
    ds_read_b64_tr_b16 a[38:39], v105 offset:23040
    v_mfma_f32_16x16x32_bf16 v[20:23], a[100:103], a[4:7], v[20:23]
    v_fma_f32 v84, v76, v84, v76
    v_fma_f32 v85, v77, v85, v77
    ds_read_b64_tr_b16 a[124:125], v105 offset:27648
    v_mfma_f32_16x16x32_bf16 v[20:23], a[8:11], a[76:79], v[20:23]
    v_fma_f32 v86, v78, v86, v78
    v_fma_f32 v87, v79, v87, v79
    ds_read_b64_tr_b16 a[126:127], v105 offset:32256
    v_mfma_f32_16x16x32_bf16 v[52:55], a[52:55], a[40:43], v[52:55]
    v_rcp_f32 v80, v80
    ds_read_b64_tr_b16 a[96:97], v105 offset:0
    v_mfma_f32_16x16x32_bf16 v[52:55], a[116:119], a[72:75], v[52:55]
    v_rcp_f32 v81, v81
    ds_read_b64_tr_b16 a[98:99], v105 offset:4608
    v_mfma_f32_16x16x32_bf16 v[52:55], a[68:71], a[60:63], v[52:55]
    v_rcp_f32 v82, v82
    ds_read_b64_tr_b16 a[88:89], v105 offset:9216
    v_mfma_f32_16x16x32_bf16 v[52:55], a[120:123], a[4:7], v[52:55]
    v_rcp_f32 v83, v83
    ds_read_b64_tr_b16 a[90:91], v105 offset:13824
    v_mfma_f32_16x16x32_bf16 v[52:55], a[48:51], a[76:79], v[52:55]
    v_rcp_f32 v84, v84
    ds_read_b64_tr_b16 a[32:33], v105 offset:59904
    s_waitcnt lgkmcnt(12)
    v_mfma_f32_16x16x32_bf16 v[24:27], a[0:3], a[112:115], v[24:27]
    v_rcp_f32 v85, v85
    v_accvgpr_write_b32 a34, 0
    v_mfma_f32_16x16x32_bf16 v[24:27], a[84:87], a[40:43], v[24:27]
    v_rcp_f32 v86, v86
    v_accvgpr_write_b32 a35, 0
    v_mfma_f32_16x16x32_bf16 v[24:27], a[80:83], a[72:75], v[24:27]
    v_rcp_f32 v87, v87
    ds_read_b64_tr_b16 a[44:45], v105 offset:18464
    v_mfma_f32_16x16x32_bf16 v[24:27], a[100:103], a[60:63], v[24:27]
    v_sub_f32 v72, s54, v72
    v_sub_f32 v73, s54, v73
    ds_read_b64_tr_b16 a[46:47], v105 offset:23072
    v_mfma_f32_16x16x32_bf16 v[24:27], a[8:11], a[4:7], v[24:27]
    v_sub_f32 v74, s54, v74
    v_sub_f32 v75, s54, v75
    ds_read_b64_tr_b16 a[108:109], v105 offset:27680
    v_mfma_f32_16x16x32_bf16 v[56:59], a[52:55], a[112:115], v[56:59]
    v_sub_f32 v76, s54, v76
    v_sub_f32 v77, s54, v77
    s_waitcnt lgkmcnt(8)
    ds_read_b64_tr_b16 a[110:111], v105 offset:32288
    v_mfma_f32_16x16x32_bf16 v[56:59], a[116:119], a[40:43], v[56:59]
    v_sub_f32 v78, s54, v78
    v_sub_f32 v79, s54, v79
    ds_read_b64_tr_b16 a[56:57], v105 offset:32
    v_mfma_f32_16x16x32_bf16 v[56:59], a[68:71], a[72:75], v[56:59]
    v_mul_f32 v72, v72, v80
    v_mul_f32 v73, v73, v81
    ds_read_b64_tr_b16 a[58:59], v105 offset:4640
    v_mfma_f32_16x16x32_bf16 v[56:59], a[120:123], a[60:63], v[56:59]
    v_mul_f32 v74, v74, v82
    v_mul_f32 v75, v75, v83
    ds_read_b64_tr_b16 a[16:17], v105 offset:9248
    v_mfma_f32_16x16x32_bf16 v[56:59], a[48:51], a[4:7], v[56:59]
    v_mul_f32 v76, v76, v84
    v_mul_f32 v77, v77, v85
    ds_read_b64_tr_b16 a[18:19], v105 offset:13856
    v_mfma_f32_16x16x32_bf16 v[28:31], a[0:3], a[12:15], v[28:31]
    v_mul_f32 v78, v78, v86
    v_mul_f32 v79, v79, v87
    ds_read_b64_tr_b16 a[92:93], v105 offset:59936
    v_mfma_f32_16x16x32_bf16 v[28:31], a[84:87], a[112:115], v[28:31]
    v_cvt_pk_bf16_f32 v80, v72, v73
    v_cvt_pk_bf16_f32 v81, v74, v75
    v_accvgpr_write_b32 a94, 0
    v_mfma_f32_16x16x32_bf16 v[28:31], a[80:83], a[40:43], v[28:31]
    v_cvt_pk_bf16_f32 v84, v76, v77
    v_cvt_pk_bf16_f32 v85, v78, v79
    v_accvgpr_write_b32 a95, 0
    v_mfma_f32_16x16x32_bf16 v[28:31], a[100:103], a[72:75], v[28:31]
    ds_write2st64_b64 v103, v[80:81], v[84:85] offset0:0 offset1:1
    v_mul_f32 v8, s52, v8
    s_waitcnt lgkmcnt(8)
    ds_read_b64_tr_b16 a[28:29], v106 offset:18688
    v_mfma_f32_16x16x32_bf16 v[28:31], a[8:11], a[60:63], v[28:31]
    v_mul_f32 v9, s52, v9
    v_mul_f32 v10, s52, v10
    ds_read_b64_tr_b16 a[30:31], v106 offset:23296
    v_mfma_f32_16x16x32_bf16 v[60:63], a[52:55], a[12:15], v[60:63]
    v_mul_f32 v11, s52, v11
    v_mul_f32 v12, s52, v12
    ds_read_b64_tr_b16 a[24:25], v106 offset:27904
    v_mfma_f32_16x16x32_bf16 v[60:63], a[116:119], a[112:115], v[60:63]
    v_mul_f32 v13, s52, v13
    v_mul_f32 v14, s52, v14
    ds_read_b64_tr_b16 a[26:27], v106 offset:32512
    v_mfma_f32_16x16x32_bf16 v[60:63], a[68:71], a[40:43], v[60:63]
    v_mul_f32 v15, s52, v15
    v_mul_f32 v40, s32, v40
    ds_read_b64_tr_b16 a[104:105], v106 offset:256
    v_mfma_f32_16x16x32_bf16 v[60:63], a[120:123], a[72:75], v[60:63]
    v_mul_f32 v41, s32, v41
    v_mul_f32 v42, s32, v42
    ds_read_b64_tr_b16 a[106:107], v106 offset:4864
    v_mfma_f32_16x16x32_bf16 v[60:63], a[48:51], a[60:63], v[60:63]
    v_mul_f32 v43, s32, v43
    v_mul_f32 v44, s32, v44
    ds_read_b64_tr_b16 a[76:77], v106 offset:9472
    v_mfma_f32_16x16x32_bf16 v[32:35], a[0:3], a[64:67], v[32:35]
    v_mul_f32 v45, s32, v45
    v_mul_f32 v46, s32, v46
    s_waitcnt lgkmcnt(8)
    ds_read_b64_tr_b16 a[78:79], v106 offset:14080
    v_mfma_f32_16x16x32_bf16 v[32:35], a[84:87], a[12:15], v[32:35]
    v_mul_f32 v47, s32, v47
    v_exp_f32 v8, v8
    ds_read_b64_tr_b16 a[4:5], v106 offset:60160
    v_mfma_f32_16x16x32_bf16 v[32:35], a[80:83], a[112:115], v[32:35]
    v_exp_f32 v9, v9
    v_accvgpr_write_b32 a6, 0
    v_mfma_f32_16x16x32_bf16 v[32:35], a[100:103], a[40:43], v[32:35]
    v_exp_f32 v10, v10
    v_accvgpr_write_b32 a7, 0
    v_mfma_f32_16x16x32_bf16 v[32:35], a[8:11], a[72:75], v[32:35]
    v_exp_f32 v11, v11
    v_mfma_f32_16x16x32_bf16 v[64:67], a[52:55], a[64:67], v[64:67]
    v_exp_f32 v12, v12
    v_mfma_f32_16x16x32_bf16 v[64:67], a[116:119], a[12:15], v[64:67]
    v_exp_f32 v13, v13
    v_mfma_f32_16x16x32_bf16 v[64:67], a[68:71], a[112:115], v[64:67]
    v_exp_f32 v14, v14
    v_mfma_f32_16x16x32_bf16 v[64:67], a[120:123], a[40:43], v[64:67]
    v_exp_f32 v15, v15
    v_mfma_f32_16x16x32_bf16 v[64:67], a[48:51], a[72:75], v[64:67]
    v_exp_f32 v40, v40
    v_mfma_f32_16x16x32_bf16 v[36:39], a[0:3], a[20:23], v[36:39]
    v_exp_f32 v41, v41
    v_mfma_f32_16x16x32_bf16 v[36:39], a[84:87], a[64:67], v[36:39]
    v_exp_f32 v42, v42
    v_mfma_f32_16x16x32_bf16 v[36:39], a[80:83], a[12:15], v[36:39]
    v_exp_f32 v43, v43
    v_mfma_f32_16x16x32_bf16 v[36:39], a[100:103], a[112:115], v[36:39]
    v_exp_f32 v44, v44
    v_mfma_f32_16x16x32_bf16 v[36:39], a[8:11], a[40:43], v[36:39]
    v_exp_f32 v45, v45
    v_mfma_f32_16x16x32_bf16 v[68:71], a[52:55], a[20:23], v[68:71]
    v_exp_f32 v46, v46
    v_mfma_f32_16x16x32_bf16 v[68:71], a[116:119], a[64:67], v[68:71]
    v_exp_f32 v47, v47
    v_mfma_f32_16x16x32_bf16 v[68:71], a[68:71], a[12:15], v[68:71]
    v_fma_f32 v8, v8, s34, s34 clamp
    v_fma_f32 v9, v9, s34, s34 clamp
    v_mfma_f32_16x16x32_bf16 v[68:71], a[120:123], a[112:115], v[68:71]
    v_fma_f32 v10, v10, s34, s34 clamp
    v_fma_f32 v11, v11, s34, s34 clamp
    v_mfma_f32_16x16x32_bf16 v[68:71], a[48:51], a[40:43], v[68:71]
    v_fma_f32 v12, v12, s34, s34 clamp
    v_fma_f32 v13, v13, s34, s34 clamp
    v_fma_f32 v14, v14, s34, s34 clamp
    v_fma_f32 v15, v15, s34, s34 clamp
    v_fma_f32 v40, v8, v40, v8
    v_fma_f32 v41, v9, v41, v9
    v_fma_f32 v42, v10, v42, v10
    v_fma_f32 v43, v11, v43, v11
    v_fma_f32 v44, v12, v44, v12
    v_fma_f32 v45, v13, v45, v13
    v_fma_f32 v46, v14, v46, v14
    v_fma_f32 v47, v15, v47, v15
    v_rcp_f32 v40, v40
    v_rcp_f32 v41, v41
    v_rcp_f32 v42, v42
    v_rcp_f32 v43, v43
    v_rcp_f32 v44, v44
    v_rcp_f32 v45, v45
    v_rcp_f32 v46, v46
    v_rcp_f32 v47, v47
    v_sub_f32 v8, s54, v8
    v_sub_f32 v9, s54, v9
    v_sub_f32 v10, s54, v10
    v_sub_f32 v11, s54, v11
    v_sub_f32 v12, s54, v12
    v_sub_f32 v13, s54, v13
    v_sub_f32 v14, s54, v14
    v_sub_f32 v15, s54, v15
    v_mul_f32 v8, v8, v40
    v_mul_f32 v9, v9, v41
    v_mul_f32 v10, v10, v42
    v_mul_f32 v11, v11, v43
    v_mul_f32 v12, v12, v44
    v_mul_f32 v13, v13, v45
    v_mul_f32 v14, v14, v46
    v_mul_f32 v15, v15, v47
    v_cvt_pk_bf16_f32 v40, v8, v9
    v_cvt_pk_bf16_f32 v41, v10, v11
    v_cvt_pk_bf16_f32 v44, v12, v13
    v_cvt_pk_bf16_f32 v45, v14, v15
    ds_write2st64_b64 v107, v[40:41], v[44:45] offset0:0 offset1:2
    v_accvgpr_write_b32 a82, 0
    v_accvgpr_write_b32 a83, 0
    v_accvgpr_write_b32 a118, 0
    v_accvgpr_write_b32 a119, 0
    v_pk_mul_f32 v[16:17], v[16:17], s[52:53]
    v_pk_mul_f32 v[18:19], v[18:19], s[52:53]
    v_pk_mul_f32 v[20:21], v[20:21], s[52:53]
    v_pk_mul_f32 v[22:23], v[22:23], s[52:53]
    v_pk_mul_f32 v[48:49], v[48:49], s[32:33]
    v_pk_mul_f32 v[50:51], v[50:51], s[32:33]
    v_pk_mul_f32 v[52:53], v[52:53], s[32:33]
    v_pk_mul_f32 v[54:55], v[54:55], s[32:33]
    v_exp_f32 v16, v16
    v_exp_f32 v17, v17
    v_exp_f32 v18, v18
    v_exp_f32 v19, v19
    v_exp_f32 v20, v20
    v_exp_f32 v21, v21
    v_exp_f32 v22, v22
    v_exp_f32 v23, v23
    v_exp_f32 v48, v48
    v_exp_f32 v49, v49
    v_exp_f32 v50, v50
    v_exp_f32 v51, v51
    v_exp_f32 v52, v52
    v_exp_f32 v53, v53
    v_exp_f32 v54, v54
    v_exp_f32 v55, v55
    s_waitcnt lgkmcnt(0)
    s_barrier
    ds_read_b128 a[60:63], v108 offset:0
    ds_read_b128 a[72:75], v108 offset:8192
    ds_read_b128 a[0:3], v108 offset:16384
    ds_read_b128 a[84:87], v108 offset:24576
    ds_read_b64 a[80:81], v109 offset:0
    v_pk_fma_f32 v[16:17], v[16:17], s[34:35], s[34:35] clamp
    v_pk_fma_f32 v[18:19], v[18:19], s[34:35], s[34:35] clamp
    v_pk_fma_f32 v[20:21], v[20:21], s[34:35], s[34:35] clamp
    v_pk_fma_f32 v[22:23], v[22:23], s[34:35], s[34:35] clamp
    v_pk_fma_f32 v[48:49], v[16:17], v[48:49], v[16:17]
    v_pk_fma_f32 v[50:51], v[18:19], v[50:51], v[18:19]
    v_pk_fma_f32 v[52:53], v[20:21], v[52:53], v[20:21]
    v_pk_fma_f32 v[54:55], v[22:23], v[54:55], v[22:23]
    s_waitcnt lgkmcnt(4)
    v_mfma_f32_16x16x32_bf16 v[8:11], a[36:39], a[60:63], 0
    v_rcp_f32 v48, v48
    s_waitcnt lgkmcnt(3)
    v_mfma_f32_16x16x32_bf16 v[8:11], a[124:127], a[72:75], v[8:11]
    v_rcp_f32 v49, v49
    s_waitcnt lgkmcnt(2)
    v_mfma_f32_16x16x32_bf16 v[8:11], a[96:99], a[0:3], v[8:11]
    v_rcp_f32 v50, v50
    s_waitcnt lgkmcnt(1)
    v_mfma_f32_16x16x32_bf16 v[8:11], a[88:91], a[84:87], v[8:11]
    v_rcp_f32 v51, v51
    s_waitcnt lgkmcnt(0)
    v_mfma_f32_16x16x32_bf16 v[8:11], a[32:35], a[80:83], v[8:11]
    v_rcp_f32 v52, v52
    v_mfma_f32_16x16x32_bf16 v[12:15], a[44:47], a[60:63], 0
    v_rcp_f32 v53, v53
    v_mfma_f32_16x16x32_bf16 v[12:15], a[108:111], a[72:75], v[12:15]
    v_rcp_f32 v54, v54
    v_mfma_f32_16x16x32_bf16 v[12:15], a[56:59], a[0:3], v[12:15]
    v_rcp_f32 v55, v55
    v_mfma_f32_16x16x32_bf16 v[12:15], a[16:19], a[84:87], v[12:15]
    v_mfma_f32_16x16x32_bf16 v[12:15], a[92:95], a[80:83], v[12:15]
    s_cmp_eq_u32 s69, 0
    s_cbranch_scc0 L_g8m0
    v_mfma_f32_16x16x32_bf16 v[72:75], a[28:31], a[60:63], 0
    v_mfma_f32_16x16x32_bf16 v[72:75], a[24:27], a[72:75], v[72:75]
    v_mfma_f32_16x16x32_bf16 v[72:75], a[104:107], a[0:3], v[72:75]
    v_mfma_f32_16x16x32_bf16 v[72:75], a[76:79], a[84:87], v[72:75]
    v_mfma_f32_16x16x32_bf16 v[72:75], a[4:7], a[80:83], v[72:75]
L_g8m0:
    v_pk_add_f32 v[16:17], s[54:55], v[16:17] neg_lo:[0,1] neg_hi:[0,1]
    v_pk_add_f32 v[18:19], s[54:55], v[18:19] neg_lo:[0,1] neg_hi:[0,1]
    v_pk_add_f32 v[20:21], s[54:55], v[20:21] neg_lo:[0,1] neg_hi:[0,1]
    v_pk_add_f32 v[22:23], s[54:55], v[22:23] neg_lo:[0,1] neg_hi:[0,1]
    v_cvt_pk_bf16_f32 v8, v8, v9
    v_cvt_pk_bf16_f32 v9, v10, v11
    ds_write_b64 v110, v[8:9] offset:0
    ds_read_b128 a[100:103], v112 offset:0
    ds_read_b128 a[8:11], v112 offset:8192
    ds_read_b128 a[52:55], v112 offset:16384
    ds_read_b128 a[20:23], v112 offset:24576
    ds_read_b64 a[116:117], v113 offset:0
    v_pk_mul_f32 v[16:17], v[16:17], v[48:49]
    v_pk_mul_f32 v[18:19], v[18:19], v[50:51]
    v_pk_mul_f32 v[20:21], v[20:21], v[52:53]
    v_pk_mul_f32 v[22:23], v[22:23], v[54:55]
    v_cvt_pk_bf16_f32 v12, v12, v13
    v_cvt_pk_bf16_f32 v13, v14, v15
    ds_write_b64 v110, v[12:13] offset:32
    v_cvt_pk_bf16_f32 v48, v16, v17
    v_cvt_pk_bf16_f32 v49, v18, v19
    v_cvt_pk_bf16_f32 v52, v20, v21
    v_cvt_pk_bf16_f32 v53, v22, v23
    ds_write2st64_b64 v107, v[48:49], v[52:53] offset0:4 offset1:6
    v_pk_mul_f32 v[24:25], v[24:25], s[52:53]
    v_pk_mul_f32 v[26:27], v[26:27], s[52:53]
    v_pk_mul_f32 v[28:29], v[28:29], s[52:53]
    s_cbranch_scc0 L_g8w0
    v_cvt_pk_bf16_f32 v72, v72, v73
    v_cvt_pk_bf16_f32 v73, v74, v75
    ds_write_b64 v111, v[72:73] offset:0
L_g8w0:
    v_pk_mul_f32 v[30:31], v[30:31], s[52:53]
    v_pk_mul_f32 v[56:57], v[56:57], s[32:33]
    v_pk_mul_f32 v[58:59], v[58:59], s[32:33]
    v_pk_mul_f32 v[60:61], v[60:61], s[32:33]
    v_pk_mul_f32 v[62:63], v[62:63], s[32:33]
    s_waitcnt lgkmcnt(6)
    v_mfma_f32_16x16x32_bf16 v[40:43], a[36:39], a[100:103], 0
    v_exp_f32 v24, v24
    s_waitcnt lgkmcnt(5)
    v_mfma_f32_16x16x32_bf16 v[40:43], a[124:127], a[8:11], v[40:43]
    v_exp_f32 v25, v25
    s_waitcnt lgkmcnt(4)
    v_mfma_f32_16x16x32_bf16 v[40:43], a[96:99], a[52:55], v[40:43]
    v_exp_f32 v26, v26
    s_waitcnt lgkmcnt(3)
    v_mfma_f32_16x16x32_bf16 v[40:43], a[88:91], a[20:23], v[40:43]
    v_exp_f32 v27, v27
    s_waitcnt lgkmcnt(2)
    v_mfma_f32_16x16x32_bf16 v[40:43], a[32:35], a[116:119], v[40:43]
    v_exp_f32 v28, v28
    v_mfma_f32_16x16x32_bf16 v[44:47], a[44:47], a[100:103], 0
    v_exp_f32 v29, v29
    v_mfma_f32_16x16x32_bf16 v[44:47], a[108:111], a[8:11], v[44:47]
    v_exp_f32 v30, v30
    v_mfma_f32_16x16x32_bf16 v[44:47], a[56:59], a[52:55], v[44:47]
    v_exp_f32 v31, v31
    v_mfma_f32_16x16x32_bf16 v[44:47], a[16:19], a[20:23], v[44:47]
    v_exp_f32 v56, v56
    v_mfma_f32_16x16x32_bf16 v[44:47], a[92:95], a[116:119], v[44:47]
    v_exp_f32 v57, v57
    v_cvt_pk_bf16_f32 v40, v40, v41
    v_cvt_pk_bf16_f32 v41, v42, v43
    ds_write_b64 v114, v[40:41] offset:0
    v_exp_f32 v58, v58
    v_exp_f32 v59, v59
    v_exp_f32 v60, v60
    v_exp_f32 v61, v61
    v_cvt_pk_bf16_f32 v44, v44, v45
    v_cvt_pk_bf16_f32 v45, v46, v47
    ds_write_b64 v114, v[44:45] offset:32
    v_exp_f32 v62, v62
    v_exp_f32 v63, v63
    s_waitcnt lgkmcnt(0)
    s_barrier
    ds_read_b128 a[60:63], v108 offset:2048
    ds_read_b128 a[72:75], v108 offset:10240
    ds_read_b128 a[0:3], v108 offset:18432
    ds_read_b128 a[84:87], v108 offset:26624
    ds_read_b64 a[80:81], v109 offset:1024
    v_pk_fma_f32 v[24:25], v[24:25], s[34:35], s[34:35] clamp
    v_pk_fma_f32 v[26:27], v[26:27], s[34:35], s[34:35] clamp
    v_pk_fma_f32 v[28:29], v[28:29], s[34:35], s[34:35] clamp
    v_pk_fma_f32 v[30:31], v[30:31], s[34:35], s[34:35] clamp
    v_pk_fma_f32 v[56:57], v[24:25], v[56:57], v[24:25]
    v_pk_fma_f32 v[58:59], v[26:27], v[58:59], v[26:27]
    v_pk_fma_f32 v[60:61], v[28:29], v[60:61], v[28:29]
    v_pk_fma_f32 v[62:63], v[30:31], v[62:63], v[30:31]
    s_waitcnt lgkmcnt(4)
    v_mfma_f32_16x16x32_bf16 v[16:19], a[36:39], a[60:63], 0
    v_rcp_f32 v56, v56
    s_waitcnt lgkmcnt(3)
    v_mfma_f32_16x16x32_bf16 v[16:19], a[124:127], a[72:75], v[16:19]
    v_rcp_f32 v57, v57
    s_waitcnt lgkmcnt(2)
    v_mfma_f32_16x16x32_bf16 v[16:19], a[96:99], a[0:3], v[16:19]
    v_rcp_f32 v58, v58
    s_waitcnt lgkmcnt(1)
    v_mfma_f32_16x16x32_bf16 v[16:19], a[88:91], a[84:87], v[16:19]
    v_rcp_f32 v59, v59
    s_waitcnt lgkmcnt(0)
    v_mfma_f32_16x16x32_bf16 v[16:19], a[32:35], a[80:83], v[16:19]
    v_rcp_f32 v60, v60
    v_mfma_f32_16x16x32_bf16 v[20:23], a[44:47], a[60:63], 0
    v_rcp_f32 v61, v61
    v_mfma_f32_16x16x32_bf16 v[20:23], a[108:111], a[72:75], v[20:23]
    v_rcp_f32 v62, v62
    v_mfma_f32_16x16x32_bf16 v[20:23], a[56:59], a[0:3], v[20:23]
    v_rcp_f32 v63, v63
    v_mfma_f32_16x16x32_bf16 v[20:23], a[16:19], a[84:87], v[20:23]
    v_mfma_f32_16x16x32_bf16 v[20:23], a[92:95], a[80:83], v[20:23]
    s_cmp_eq_u32 s69, 1
    s_cbranch_scc0 L_g8m1
    v_mfma_f32_16x16x32_bf16 v[72:75], a[28:31], a[60:63], 0
    v_mfma_f32_16x16x32_bf16 v[72:75], a[24:27], a[72:75], v[72:75]
    v_mfma_f32_16x16x32_bf16 v[72:75], a[104:107], a[0:3], v[72:75]
    v_mfma_f32_16x16x32_bf16 v[72:75], a[76:79], a[84:87], v[72:75]
    v_mfma_f32_16x16x32_bf16 v[72:75], a[4:7], a[80:83], v[72:75]
L_g8m1:
    v_pk_add_f32 v[24:25], s[54:55], v[24:25] neg_lo:[0,1] neg_hi:[0,1]
    v_pk_add_f32 v[26:27], s[54:55], v[26:27] neg_lo:[0,1] neg_hi:[0,1]
    v_pk_add_f32 v[28:29], s[54:55], v[28:29] neg_lo:[0,1] neg_hi:[0,1]
    v_pk_add_f32 v[30:31], s[54:55], v[30:31] neg_lo:[0,1] neg_hi:[0,1]
    v_cvt_pk_bf16_f32 v16, v16, v17
    v_cvt_pk_bf16_f32 v17, v18, v19
    ds_write_b64 v110, v[16:17] offset:9344
    ds_read_b128 a[100:103], v112 offset:2048
    ds_read_b128 a[8:11], v112 offset:10240
    ds_read_b128 a[52:55], v112 offset:18432
    ds_read_b128 a[20:23], v112 offset:26624
    ds_read_b64 a[116:117], v113 offset:1024
    v_pk_mul_f32 v[24:25], v[24:25], v[56:57]
    v_pk_mul_f32 v[26:27], v[26:27], v[58:59]
    v_pk_mul_f32 v[28:29], v[28:29], v[60:61]
    v_pk_mul_f32 v[30:31], v[30:31], v[62:63]
    v_cvt_pk_bf16_f32 v20, v20, v21
    v_cvt_pk_bf16_f32 v21, v22, v23
    ds_write_b64 v110, v[20:21] offset:9376
    v_cvt_pk_bf16_f32 v56, v24, v25
    v_cvt_pk_bf16_f32 v57, v26, v27
    v_cvt_pk_bf16_f32 v60, v28, v29
    v_cvt_pk_bf16_f32 v61, v30, v31
    ds_write2st64_b64 v107, v[56:57], v[60:61] offset0:8 offset1:10
    v_pk_mul_f32 v[32:33], v[32:33], s[52:53]
    v_pk_mul_f32 v[34:35], v[34:35], s[52:53]
    v_pk_mul_f32 v[36:37], v[36:37], s[52:53]
    s_cbranch_scc0 L_g8w1
    v_cvt_pk_bf16_f32 v72, v72, v73
    v_cvt_pk_bf16_f32 v73, v74, v75
    ds_write_b64 v111, v[72:73] offset:9344
L_g8w1:
    v_pk_mul_f32 v[38:39], v[38:39], s[52:53]
    v_pk_mul_f32 v[64:65], v[64:65], s[32:33]
    v_pk_mul_f32 v[66:67], v[66:67], s[32:33]
    v_pk_mul_f32 v[68:69], v[68:69], s[32:33]
    v_pk_mul_f32 v[70:71], v[70:71], s[32:33]
    s_waitcnt lgkmcnt(6)
    v_mfma_f32_16x16x32_bf16 v[48:51], a[36:39], a[100:103], 0
    v_exp_f32 v32, v32
    s_waitcnt lgkmcnt(5)
    v_mfma_f32_16x16x32_bf16 v[48:51], a[124:127], a[8:11], v[48:51]
    v_exp_f32 v33, v33
    s_waitcnt lgkmcnt(4)
    v_mfma_f32_16x16x32_bf16 v[48:51], a[96:99], a[52:55], v[48:51]
    v_exp_f32 v34, v34
    s_waitcnt lgkmcnt(3)
    v_mfma_f32_16x16x32_bf16 v[48:51], a[88:91], a[20:23], v[48:51]
    v_exp_f32 v35, v35
    s_waitcnt lgkmcnt(2)
    v_mfma_f32_16x16x32_bf16 v[48:51], a[32:35], a[116:119], v[48:51]
    v_exp_f32 v36, v36
    v_mfma_f32_16x16x32_bf16 v[52:55], a[44:47], a[100:103], 0
    v_exp_f32 v37, v37
    v_mfma_f32_16x16x32_bf16 v[52:55], a[108:111], a[8:11], v[52:55]
    v_exp_f32 v38, v38
    v_mfma_f32_16x16x32_bf16 v[52:55], a[56:59], a[52:55], v[52:55]
    v_exp_f32 v39, v39
    v_mfma_f32_16x16x32_bf16 v[52:55], a[16:19], a[20:23], v[52:55]
    v_exp_f32 v64, v64
    v_mfma_f32_16x16x32_bf16 v[52:55], a[92:95], a[116:119], v[52:55]
    v_exp_f32 v65, v65
    v_cvt_pk_bf16_f32 v48, v48, v49
    v_cvt_pk_bf16_f32 v49, v50, v51
    ds_write_b64 v114, v[48:49] offset:9344
    v_exp_f32 v66, v66
    v_exp_f32 v67, v67
    v_exp_f32 v68, v68
    v_exp_f32 v69, v69
    v_cvt_pk_bf16_f32 v52, v52, v53
    v_cvt_pk_bf16_f32 v53, v54, v55
    ds_write_b64 v114, v[52:53] offset:9376
    v_exp_f32 v70, v70
    v_exp_f32 v71, v71
    s_waitcnt lgkmcnt(0)
    s_barrier
    ds_read_b128 a[60:63], v108 offset:4096
    ds_read_b128 a[72:75], v108 offset:12288
    ds_read_b128 a[0:3], v108 offset:20480
    ds_read_b128 a[84:87], v108 offset:28672
    ds_read_b64 a[80:81], v109 offset:2048
    v_pk_fma_f32 v[32:33], v[32:33], s[34:35], s[34:35] clamp
    v_pk_fma_f32 v[34:35], v[34:35], s[34:35], s[34:35] clamp
    v_pk_fma_f32 v[36:37], v[36:37], s[34:35], s[34:35] clamp
    v_pk_fma_f32 v[38:39], v[38:39], s[34:35], s[34:35] clamp
    ds_read_b128 a[100:103], v112 offset:4096
    ds_read_b128 a[8:11], v112 offset:12288
    ds_read_b128 a[52:55], v112 offset:20480
    ds_read_b128 a[20:23], v112 offset:28672
    ds_read_b64 a[116:117], v113 offset:2048
    v_pk_fma_f32 v[64:65], v[32:33], v[64:65], v[32:33]
    v_pk_fma_f32 v[66:67], v[34:35], v[66:67], v[34:35]
    v_pk_fma_f32 v[68:69], v[36:37], v[68:69], v[36:37]
    v_pk_fma_f32 v[70:71], v[38:39], v[70:71], v[38:39]
    s_waitcnt lgkmcnt(9)
    v_mfma_f32_16x16x32_bf16 v[24:27], a[36:39], a[60:63], 0
    v_rcp_f32 v64, v64
    s_waitcnt lgkmcnt(8)
    v_mfma_f32_16x16x32_bf16 v[24:27], a[124:127], a[72:75], v[24:27]
    v_rcp_f32 v65, v65
    s_waitcnt lgkmcnt(7)
    v_mfma_f32_16x16x32_bf16 v[24:27], a[96:99], a[0:3], v[24:27]
    v_rcp_f32 v66, v66
    s_waitcnt lgkmcnt(6)
    v_mfma_f32_16x16x32_bf16 v[24:27], a[88:91], a[84:87], v[24:27]
    v_rcp_f32 v67, v67
    s_waitcnt lgkmcnt(5)
    v_mfma_f32_16x16x32_bf16 v[24:27], a[32:35], a[80:83], v[24:27]
    v_rcp_f32 v68, v68
    v_mfma_f32_16x16x32_bf16 v[28:31], a[44:47], a[60:63], 0
    v_rcp_f32 v69, v69
    v_mfma_f32_16x16x32_bf16 v[28:31], a[108:111], a[72:75], v[28:31]
    v_rcp_f32 v70, v70
    v_mfma_f32_16x16x32_bf16 v[28:31], a[56:59], a[0:3], v[28:31]
    v_rcp_f32 v71, v71
    v_mfma_f32_16x16x32_bf16 v[28:31], a[16:19], a[84:87], v[28:31]
    v_mfma_f32_16x16x32_bf16 v[28:31], a[92:95], a[80:83], v[28:31]
    s_waitcnt lgkmcnt(4)
    v_mfma_f32_16x16x32_bf16 v[56:59], a[36:39], a[100:103], 0
    s_waitcnt lgkmcnt(3)
    v_mfma_f32_16x16x32_bf16 v[56:59], a[124:127], a[8:11], v[56:59]
    s_waitcnt lgkmcnt(2)
    v_mfma_f32_16x16x32_bf16 v[56:59], a[96:99], a[52:55], v[56:59]
    s_waitcnt lgkmcnt(1)
    v_mfma_f32_16x16x32_bf16 v[56:59], a[88:91], a[20:23], v[56:59]
    s_waitcnt lgkmcnt(0)
    v_mfma_f32_16x16x32_bf16 v[56:59], a[32:35], a[116:119], v[56:59]
    v_mfma_f32_16x16x32_bf16 v[60:63], a[44:47], a[100:103], 0
    v_mfma_f32_16x16x32_bf16 v[60:63], a[108:111], a[8:11], v[60:63]
    v_mfma_f32_16x16x32_bf16 v[60:63], a[56:59], a[52:55], v[60:63]
    v_mfma_f32_16x16x32_bf16 v[60:63], a[16:19], a[20:23], v[60:63]
    v_mfma_f32_16x16x32_bf16 v[60:63], a[92:95], a[116:119], v[60:63]
    s_cmp_eq_u32 s69, 0
    s_cbranch_scc0 L_g8m2
    v_mfma_f32_16x16x32_bf16 v[72:75], a[28:31], a[60:63], 0
    v_mfma_f32_16x16x32_bf16 v[72:75], a[24:27], a[72:75], v[72:75]
    v_mfma_f32_16x16x32_bf16 v[72:75], a[104:107], a[0:3], v[72:75]
    v_mfma_f32_16x16x32_bf16 v[72:75], a[76:79], a[84:87], v[72:75]
    v_mfma_f32_16x16x32_bf16 v[72:75], a[4:7], a[80:83], v[72:75]
L_g8m2:
    v_pk_add_f32 v[32:33], s[54:55], v[32:33] neg_lo:[0,1] neg_hi:[0,1]
    v_pk_add_f32 v[34:35], s[54:55], v[34:35] neg_lo:[0,1] neg_hi:[0,1]
    v_pk_add_f32 v[36:37], s[54:55], v[36:37] neg_lo:[0,1] neg_hi:[0,1]
    v_pk_add_f32 v[38:39], s[54:55], v[38:39] neg_lo:[0,1] neg_hi:[0,1]
    v_cvt_pk_bf16_f32 v24, v24, v25
    v_cvt_pk_bf16_f32 v25, v26, v27
    ds_write_b64 v110, v[24:25] offset:18688
    v_pk_mul_f32 v[32:33], v[32:33], v[64:65]
    v_pk_mul_f32 v[34:35], v[34:35], v[66:67]
    v_cvt_pk_bf16_f32 v56, v56, v57
    v_cvt_pk_bf16_f32 v57, v58, v59
    ds_write_b64 v114, v[56:57] offset:18688
    v_pk_mul_f32 v[36:37], v[36:37], v[68:69]
    v_pk_mul_f32 v[38:39], v[38:39], v[70:71]
    v_cvt_pk_bf16_f32 v28, v28, v29
    v_cvt_pk_bf16_f32 v29, v30, v31
    ds_write_b64 v110, v[28:29] offset:18720
    v_cvt_pk_bf16_f32 v64, v32, v33
    v_cvt_pk_bf16_f32 v65, v34, v35
    v_cvt_pk_bf16_f32 v60, v60, v61
    v_cvt_pk_bf16_f32 v61, v62, v63
    ds_write_b64 v114, v[60:61] offset:18720
    v_cvt_pk_bf16_f32 v68, v36, v37
    v_cvt_pk_bf16_f32 v69, v38, v39
    s_cbranch_scc0 L_g8w2
    v_cvt_pk_bf16_f32 v72, v72, v73
    v_cvt_pk_bf16_f32 v73, v74, v75
    ds_write_b64 v111, v[72:73] offset:18688
L_g8w2:
    ds_write2st64_b64 v107, v[64:65], v[68:69] offset0:12 offset1:14
    s_waitcnt lgkmcnt(0)
    s_barrier
    ds_read_b128 a[60:63], v108 offset:6144
    ds_read_b128 a[72:75], v108 offset:14336
    ds_read_b128 a[0:3], v108 offset:22528
    ds_read_b128 a[84:87], v108 offset:30720
    ds_read_b64 a[80:81], v109 offset:3072
    s_waitcnt lgkmcnt(4)
    v_mfma_f32_16x16x32_bf16 v[32:35], a[36:39], a[60:63], 0
    s_waitcnt lgkmcnt(3)
    v_mfma_f32_16x16x32_bf16 v[32:35], a[124:127], a[72:75], v[32:35]
    s_waitcnt lgkmcnt(2)
    v_mfma_f32_16x16x32_bf16 v[32:35], a[96:99], a[0:3], v[32:35]
    s_waitcnt lgkmcnt(1)
    v_mfma_f32_16x16x32_bf16 v[32:35], a[88:91], a[84:87], v[32:35]
    s_waitcnt lgkmcnt(0)
    v_mfma_f32_16x16x32_bf16 v[32:35], a[32:35], a[80:83], v[32:35]
    v_mfma_f32_16x16x32_bf16 v[36:39], a[44:47], a[60:63], 0
    v_mfma_f32_16x16x32_bf16 v[36:39], a[108:111], a[72:75], v[36:39]
    v_mfma_f32_16x16x32_bf16 v[36:39], a[56:59], a[0:3], v[36:39]
    v_mfma_f32_16x16x32_bf16 v[36:39], a[16:19], a[84:87], v[36:39]
    v_mfma_f32_16x16x32_bf16 v[36:39], a[92:95], a[80:83], v[36:39]
    s_cmp_eq_u32 s69, 1
    s_cbranch_scc0 L_g8m3
    v_mfma_f32_16x16x32_bf16 v[72:75], a[28:31], a[60:63], 0
    v_mfma_f32_16x16x32_bf16 v[72:75], a[24:27], a[72:75], v[72:75]
    v_mfma_f32_16x16x32_bf16 v[72:75], a[104:107], a[0:3], v[72:75]
    v_mfma_f32_16x16x32_bf16 v[72:75], a[76:79], a[84:87], v[72:75]
    v_mfma_f32_16x16x32_bf16 v[72:75], a[4:7], a[80:83], v[72:75]
L_g8m3:
    s_nop 0
    v_cvt_pk_bf16_f32 v32, v32, v33
    v_cvt_pk_bf16_f32 v33, v34, v35
    ds_write_b64 v110, v[32:33] offset:28032
    s_nop 1
    v_cvt_pk_bf16_f32 v36, v36, v37
    v_cvt_pk_bf16_f32 v37, v38, v39
    ds_write_b64 v110, v[36:37] offset:28064
    s_cbranch_scc0 L_g8w3
    v_cvt_pk_bf16_f32 v72, v72, v73
    v_cvt_pk_bf16_f32 v73, v74, v75
    ds_write_b64 v111, v[72:73] offset:28032
L_g8w3:
    s_waitcnt lgkmcnt(0)
    s_barrier
    s_endpgm
L_grpB:
    s_waitcnt vmcnt(6)
    s_barrier
    ds_read_b64_tr_b16 a[0:1], v116 offset:0
    ds_read_b64 a[4:5], v103 offset:0
    ds_read_b64 a[8:9], v103 offset:64
    ds_read_b64 a[12:13], v103 offset:128
    ds_read_b64 a[16:17], v103 offset:192
    ds_read_b64 a[20:21], v103 offset:256
    s_setprio 3
    s_add_u32 m0, s43, 0
    s_movk_i32 s30, 0
    buffer_load_dwordx4 v104, s[12:15], s30 offen lds
    s_setprio 1
    s_waitcnt lgkmcnt(4)
    v_mfma_f32_16x16x16_bf16 v[8:11], a[0:1], a[4:5], 0
    ds_read_b64 a[24:25], v103 offset:320
    ds_read_b64 a[28:29], v103 offset:384
    ds_read_b64 a[32:33], v103 offset:448
    s_waitcnt lgkmcnt(6)
    v_mfma_f32_16x16x16_bf16 v[12:15], a[0:1], a[8:9], 0
    ds_read_b64_tr_b16 a[36:37], v117 offset:0
    s_waitcnt lgkmcnt(6)
    v_mfma_f32_16x16x16_bf16 v[16:19], a[0:1], a[12:13], 0
    ds_read_b128 a[40:43], v120 offset:256
    s_waitcnt lgkmcnt(6)
    v_mfma_f32_16x16x16_bf16 v[20:23], a[0:1], a[16:17], 0
    ds_read_b128 a[44:47], v120 offset:320
    s_waitcnt lgkmcnt(6)
    v_mfma_f32_16x16x16_bf16 v[24:27], a[0:1], a[20:21], 0
    ds_read_b128 a[48:51], v120 offset:384
    s_waitcnt lgkmcnt(6)
    v_mfma_f32_16x16x16_bf16 v[28:31], a[0:1], a[24:25], 0
    ds_read_b128 a[52:55], v120 offset:448
    s_waitcnt lgkmcnt(6)
    v_mfma_f32_16x16x16_bf16 v[32:35], a[0:1], a[28:29], 0
    ds_read_b128 a[56:59], v121 offset:544
    s_waitcnt lgkmcnt(6)
    v_mfma_f32_16x16x16_bf16 v[36:39], a[0:1], a[32:33], 0
    ds_read_b128 a[60:63], v120 offset:608
    s_waitcnt lgkmcnt(6)
    v_mfma_f32_16x16x16_bf16 v[40:43], a[36:37], a[4:5], 0
    ds_read_b128 a[64:67], v120 offset:672
    v_mfma_f32_16x16x16_bf16 v[44:47], a[36:37], a[8:9], 0
    ds_read_b128 a[68:71], v120 offset:736
    ds_read_b128 a[72:75], v120 offset:128
    s_waitcnt vmcnt(2)
    s_barrier
    v_mfma_f32_16x16x16_bf16 v[48:51], a[36:37], a[12:13], 0
    ds_read_b64_tr_b16 a[76:77], v91 offset:18432
    ds_read_b64_tr_b16 a[78:79], v91 offset:20736
    v_mfma_f32_16x16x16_bf16 v[52:55], a[36:37], a[16:17], 0
    ds_read_b64_tr_b16 a[80:81], v92 offset:18432
    v_mfma_f32_16x16x16_bf16 v[56:59], a[36:37], a[20:21], 0
    ds_read_b64_tr_b16 a[82:83], v92 offset:20736
    v_mfma_f32_16x16x16_bf16 v[60:63], a[36:37], a[24:25], 0
    ds_read_b128 a[84:87], v120 offset:192
    v_mfma_f32_16x16x16_bf16 v[64:67], a[36:37], a[28:29], 0
    v_mfma_f32_16x16x16_bf16 v[68:71], a[36:37], a[32:33], 0
    s_mov_b32 s20, s8
    s_waitcnt lgkmcnt(3)
    v_mfma_f32_16x16x32_bf16 v[8:11], a[76:79], a[40:43], v[8:11]
    s_mov_b32 s21, s9
    v_mfma_f32_16x16x32_bf16 v[12:15], a[76:79], a[44:47], v[12:15]
    s_mov_b32 s22, 41472
    v_mfma_f32_16x16x32_bf16 v[16:19], a[76:79], a[48:51], v[16:19]
    s_mov_b32 s23, 0x20000
    v_mfma_f32_16x16x32_bf16 v[20:23], a[76:79], a[52:55], v[20:23]
    v_lshlrev_b32 v90, 4, v88
    v_mfma_f32_16x16x32_bf16 v[24:27], a[76:79], a[56:59], v[24:27]
    s_mov_b32 s32, 0xbfb8aa3b
    v_mfma_f32_16x16x32_bf16 v[28:31], a[76:79], a[60:63], v[28:31]
    s_mov_b32 s33, 0xbfb8aa3b
    v_mfma_f32_16x16x32_bf16 v[32:35], a[76:79], a[64:67], v[32:35]
    s_mov_b32 s34, 0x2f800000
    v_mfma_f32_16x16x32_bf16 v[36:39], a[76:79], a[68:71], v[36:39]
    s_mov_b32 s35, 0x2f800000
    s_waitcnt lgkmcnt(1)
    v_mfma_f32_16x16x32_bf16 v[40:43], a[80:83], a[40:43], v[40:43]
    s_mov_b32 s52, 0xc038aa3b
    v_mfma_f32_16x16x32_bf16 v[44:47], a[80:83], a[44:47], v[44:47]
    s_mov_b32 s53, 0xc038aa3b
    s_barrier
    s_setprio 3
    s_add_u32 m0, s29, 73728
    s_add_u32 s30, s29, 82944
    s_mov_b32 exec_hi, 0
    buffer_load_dwordx4 v89, s[16:19], s30 offen lds
    s_mov_b32 exec_hi, -1
    buffer_load_dwordx4 v89, s[16:19], s30 offen offset:512 lds
    buffer_load_dwordx4 v89, s[16:19], s30 offen offset:1536 lds
    buffer_load_dwordx4 v89, s[16:19], s30 offen offset:2560 lds
    buffer_load_dwordx4 v89, s[16:19], s30 offen offset:3584 lds
    s_setprio 1
    v_mfma_f32_16x16x32_bf16 v[48:51], a[80:83], a[48:51], v[48:51]
    ds_read_b64_tr_b16 a[88:89], v91 offset:36864
    ds_read_b64_tr_b16 a[90:91], v91 offset:39168
    v_mfma_f32_16x16x32_bf16 v[52:55], a[80:83], a[52:55], v[52:55]
    ds_read_b64_tr_b16 a[92:93], v92 offset:36864
    v_mfma_f32_16x16x32_bf16 v[56:59], a[80:83], a[56:59], v[56:59]
    ds_read_b64_tr_b16 a[94:95], v92 offset:39168
    v_mfma_f32_16x16x32_bf16 v[60:63], a[80:83], a[60:63], v[60:63]
    s_mov_b32 s54, 0x30000000
    v_mfma_f32_16x16x32_bf16 v[64:67], a[80:83], a[64:67], v[64:67]
    s_mov_b32 s55, 0x30000000
    v_mfma_f32_16x16x32_bf16 v[68:71], a[80:83], a[68:71], v[68:71]
    s_lshr_b32 s69, s3, 1
    s_waitcnt lgkmcnt(2)
    v_mfma_f32_16x16x32_bf16 v[8:11], a[88:91], a[72:75], v[8:11]
    s_lshl_b32 s45, s44, 6
    v_mfma_f32_16x16x32_bf16 v[12:15], a[88:91], a[84:87], v[12:15]
    v_add_u32 v106, 92160, v106
    v_mfma_f32_16x16x32_bf16 v[16:19], a[88:91], a[40:43], v[16:19]
    v_add_u32 v105, s45, v106
    v_mfma_f32_16x16x32_bf16 v[20:23], a[88:91], a[44:47], v[20:23]
    v_mul_u32_u24 v3, 1168, v3
    v_mfma_f32_16x16x32_bf16 v[24:27], a[88:91], a[48:51], v[24:27]
    v_mul_u32_u24 v4, 288, v4
    v_mfma_f32_16x16x32_bf16 v[28:31], a[88:91], a[52:55], v[28:31]
    v_lshl_add_u32 v3, v2, 3, v3
    v_mfma_f32_16x16x32_bf16 v[32:35], a[88:91], a[56:59], v[32:35]
    v_add_u32 v3, v3, v4
    v_mfma_f32_16x16x32_bf16 v[36:39], a[88:91], a[60:63], v[36:39]
    s_and_b32 s47, s3, 1
    s_waitcnt vmcnt(5) lgkmcnt(0)
    s_barrier
    s_setprio 3
    s_add_u32 m0, s29, 0
    s_add_u32 s30, s29, 248832
    s_mov_b32 exec_hi, 0
    buffer_load_dwordx4 v89, s[16:19], s30 offen lds
    s_mov_b32 exec_hi, -1
    buffer_load_dwordx4 v89, s[16:19], s30 offen offset:512 lds
    buffer_load_dwordx4 v89, s[16:19], s30 offen offset:1536 lds
    buffer_load_dwordx4 v89, s[16:19], s30 offen offset:2560 lds
    buffer_load_dwordx4 v89, s[16:19], s30 offen offset:3584 lds
    s_setprio 1
    v_mfma_f32_16x16x32_bf16 v[40:43], a[92:95], a[72:75], v[40:43]
    ds_read_b64_tr_b16 a[96:97], v95 offset:0
    ds_read_b64_tr_b16 a[98:99], v95 offset:2304
    ds_read_b128 a[100:103], v99 offset:512
    v_mfma_f32_16x16x32_bf16 v[44:47], a[92:95], a[84:87], v[44:47]
    ds_read_b128 a[104:107], v99 offset:640
    ds_read_b128 a[108:111], v99 offset:768
    v_mfma_f32_16x16x32_bf16 v[48:51], a[92:95], a[40:43], v[48:51]
    ds_read_b128 a[112:115], v99 offset:896
    v_mfma_f32_16x16x32_bf16 v[52:55], a[92:95], a[44:47], v[52:55]
    ds_read_b128 a[116:119], v99 offset:1056
    v_mfma_f32_16x16x32_bf16 v[56:59], a[92:95], a[48:51], v[56:59]
    ds_read_b128 a[120:123], v99 offset:1184
    v_mfma_f32_16x16x32_bf16 v[60:63], a[92:95], a[52:55], v[60:63]
    ds_read_b128 a[124:127], v99 offset:1312
    v_mfma_f32_16x16x32_bf16 v[64:67], a[92:95], a[56:59], v[64:67]
    ds_read_b128 a[0:3], v99 offset:1440
    v_mfma_f32_16x16x32_bf16 v[68:71], a[92:95], a[60:63], v[68:71]
    ds_read_b64_tr_b16 a[4:5], v96 offset:0
    ds_read_b64_tr_b16 a[6:7], v96 offset:2304
    s_waitcnt lgkmcnt(9)
    v_mfma_f32_16x16x32_bf16 v[8:11], a[96:99], a[100:103], v[8:11]
    ds_read_b128 a[8:11], v99 offset:384
    s_waitcnt lgkmcnt(9)
    v_mfma_f32_16x16x32_bf16 v[12:15], a[96:99], a[104:107], v[12:15]
    ds_read_b128 a[12:15], v99 offset:256
    s_waitcnt lgkmcnt(9)
    v_mfma_f32_16x16x32_bf16 v[16:19], a[96:99], a[108:111], v[16:19]
    ds_read_b128 a[16:19], v99 offset:128
    s_waitcnt lgkmcnt(9)
    v_mfma_f32_16x16x32_bf16 v[20:23], a[96:99], a[112:115], v[20:23]
    s_xor_b32 s46, s47, 1
    s_waitcnt lgkmcnt(8)
    v_mfma_f32_16x16x32_bf16 v[24:27], a[96:99], a[116:119], v[24:27]
    ds_read_b128 a[20:23], v99 offset:0
    s_waitcnt lgkmcnt(8)
    v_mfma_f32_16x16x32_bf16 v[28:31], a[96:99], a[120:123], v[28:31]
    s_mul_i32 s68, s46, 576
    s_waitcnt lgkmcnt(7)
    v_mfma_f32_16x16x32_bf16 v[32:35], a[96:99], a[124:127], v[32:35]
    s_add_u32 s45, s45, s68
    s_waitcnt lgkmcnt(6)
    v_mfma_f32_16x16x32_bf16 v[36:39], a[96:99], a[0:3], v[36:39]
    s_add_u32 s45, s45, 36864
    s_waitcnt vmcnt(5) lgkmcnt(4)
    s_barrier
    s_setprio 3
    s_add_u32 m0, s43, 8960
    s_movk_i32 s30, 64
    buffer_load_dwordx4 v104, s[12:15], s30 offen lds
    s_setprio 1
    v_mfma_f32_16x16x32_bf16 v[40:43], a[4:7], a[100:103], v[40:43]
    ds_read_b64_tr_b16 a[24:25], v95 offset:18432
    ds_read_b64_tr_b16 a[26:27], v95 offset:20736
    v_mfma_f32_16x16x32_bf16 v[44:47], a[4:7], a[104:107], v[44:47]
    ds_read_b64_tr_b16 a[28:29], v96 offset:18432
    v_mfma_f32_16x16x32_bf16 v[48:51], a[4:7], a[108:111], v[48:51]
    ds_read_b64_tr_b16 a[30:31], v96 offset:20736
    v_mfma_f32_16x16x32_bf16 v[52:55], a[4:7], a[112:115], v[52:55]
    ds_read_b64_tr_b16 a[36:37], v95 offset:36864
    v_mfma_f32_16x16x32_bf16 v[56:59], a[4:7], a[116:119], v[56:59]
    ds_read_b64_tr_b16 a[38:39], v95 offset:39168
    v_mfma_f32_16x16x32_bf16 v[60:63], a[4:7], a[120:123], v[60:63]
    ds_read_b64_tr_b16 a[32:33], v96 offset:36864
    v_mfma_f32_16x16x32_bf16 v[64:67], a[4:7], a[124:127], v[64:67]
    ds_read_b64_tr_b16 a[34:35], v96 offset:39168
    v_mfma_f32_16x16x32_bf16 v[68:71], a[4:7], a[0:3], v[68:71]
    v_add_u32 v110, s45, v3
    s_waitcnt lgkmcnt(6)
    v_mfma_f32_16x16x32_bf16 v[8:11], a[24:27], a[8:11], v[8:11]
    s_lshl_b32 s45, s46, 10
    v_mfma_f32_16x16x32_bf16 v[12:15], a[24:27], a[100:103], v[12:15]
    v_add_u32 v108, s45, v90
    v_mfma_f32_16x16x32_bf16 v[16:19], a[24:27], a[104:107], v[16:19]
    s_lshl_b32 s45, s46, 9
    v_mfma_f32_16x16x32_bf16 v[20:23], a[24:27], a[108:111], v[20:23]
    s_add_u32 s45, s45, 32768
    v_mfma_f32_16x16x32_bf16 v[24:27], a[24:27], a[112:115], v[24:27]
    v_lshl_add_u32 v109, v88, 3, s45
    v_mfma_f32_16x16x32_bf16 v[28:31], a[24:27], a[116:119], v[28:31]
    s_lshl_b32 s45, s69, 13
    v_mfma_f32_16x16x32_bf16 v[32:35], a[24:27], a[120:123], v[32:35]
    s_lshl3_add_u32 s45, s47, s45
    v_mfma_f32_16x16x32_bf16 v[36:39], a[24:27], a[124:127], v[36:39]
    v_add_u32 v107, s45, v90
    s_waitcnt lgkmcnt(4)
    v_mfma_f32_16x16x32_bf16 v[40:43], a[28:31], a[8:11], v[40:43]
    s_and_b32 s69, s69, 1
    v_mfma_f32_16x16x32_bf16 v[44:47], a[28:31], a[100:103], v[44:47]
    s_add_u32 s24, s10, s37
    s_addc_u32 s25, s11, 0
    v_mfma_f32_16x16x32_bf16 v[48:51], a[28:31], a[104:107], v[48:51]
    s_mov_b32 s26, 4608000
    v_mfma_f32_16x16x32_bf16 v[52:55], a[28:31], a[108:111], v[52:55]
    s_mov_b32 s27, 0x20000
    v_mfma_f32_16x16x32_bf16 v[56:59], a[28:31], a[112:115], v[56:59]
    s_mul_i32 s45, s44, 2336
    v_mfma_f32_16x16x32_bf16 v[60:63], a[28:31], a[116:119], v[60:63]
    s_add_u32 s45, s45, 36864
    v_mfma_f32_16x16x32_bf16 v[64:67], a[28:31], a[120:123], v[64:67]
    v_add_u32 v112, s45, v90
    v_mfma_f32_16x16x32_bf16 v[68:71], a[28:31], a[124:127], v[68:71]
    s_lshl_b32 s68, s29, 1
    s_waitcnt vmcnt(1) lgkmcnt(0)
    s_barrier
    s_setprio 3
    s_add_u32 m0, s29, 55296
    s_add_u32 s30, s29, 101376
    s_mov_b32 exec_hi, 0
    buffer_load_dwordx4 v89, s[16:19], s30 offen lds
    s_mov_b32 exec_hi, -1
    buffer_load_dwordx4 v89, s[16:19], s30 offen offset:512 lds
    buffer_load_dwordx4 v89, s[16:19], s30 offen offset:1536 lds
    buffer_load_dwordx4 v89, s[16:19], s30 offen offset:2560 lds
    buffer_load_dwordx4 v89, s[16:19], s30 offen offset:3584 lds
    s_add_u32 m0, s29, 92160
    s_add_u32 s30, s29, 267264
    s_mov_b32 exec_hi, 0
    buffer_load_dwordx4 v89, s[16:19], s30 offen lds
    s_mov_b32 exec_hi, -1
    buffer_load_dwordx4 v89, s[16:19], s30 offen offset:512 lds
    buffer_load_dwordx4 v89, s[16:19], s30 offen offset:1536 lds
    buffer_load_dwordx4 v89, s[16:19], s30 offen offset:2560 lds
    buffer_load_dwordx4 v89, s[16:19], s30 offen offset:3584 lds
    s_setprio 1
    v_mfma_f32_16x16x32_bf16 v[8:11], a[36:39], a[12:15], v[8:11]
    ds_read_b64_tr_b16 a[76:77], v91 offset:0
    v_mfma_f32_16x16x32_bf16 v[12:15], a[36:39], a[8:11], v[12:15]
    ds_read_b64_tr_b16 a[78:79], v91 offset:2304
    v_mfma_f32_16x16x32_bf16 v[16:19], a[36:39], a[100:103], v[16:19]
    ds_read_b64_tr_b16 a[64:65], v92 offset:0
    v_mfma_f32_16x16x32_bf16 v[20:23], a[36:39], a[104:107], v[20:23]
    ds_read_b64_tr_b16 a[66:67], v92 offset:2304
    v_mfma_f32_16x16x32_bf16 v[24:27], a[36:39], a[108:111], v[24:27]
    ds_read_b64_tr_b16 a[80:81], v91 offset:18432
    v_mfma_f32_16x16x32_bf16 v[28:31], a[36:39], a[112:115], v[28:31]
    ds_read_b64_tr_b16 a[82:83], v91 offset:20736
    v_mfma_f32_16x16x32_bf16 v[32:35], a[36:39], a[116:119], v[32:35]
    ds_read_b64_tr_b16 a[68:69], v92 offset:18432
    v_mfma_f32_16x16x32_bf16 v[36:39], a[36:39], a[120:123], v[36:39]
    ds_read_b64_tr_b16 a[70:71], v92 offset:20736
    v_mfma_f32_16x16x32_bf16 v[40:43], a[32:35], a[12:15], v[40:43]
    s_add_u32 s68, s68, s31
    v_mfma_f32_16x16x32_bf16 v[44:47], a[32:35], a[8:11], v[44:47]
    v_add_u32 v114, s68, v90
    v_mfma_f32_16x16x32_bf16 v[48:51], a[32:35], a[100:103], v[48:51]
    v_bfe_u32 v1, v88, 3, 1
    v_mfma_f32_16x16x32_bf16 v[52:55], a[32:35], a[104:107], v[52:55]
    v_and_b32 v2, 7, v88
    v_mfma_f32_16x16x32_bf16 v[56:59], a[32:35], a[108:111], v[56:59]
    v_lshlrev_b32 v2, 4, v2
    v_mfma_f32_16x16x32_bf16 v[60:63], a[32:35], a[112:115], v[60:63]
    v_mul_u32_u24 v3, 1168, v1
    v_mfma_f32_16x16x32_bf16 v[64:67], a[32:35], a[116:119], v[64:67]
    v_add3_u32 v113, v3, v2, s45
    v_mfma_f32_16x16x32_bf16 v[68:71], a[32:35], a[120:123], v[68:71]
    v_mul_u32_u24 v3, 4608, v1
    s_waitcnt lgkmcnt(6)
    v_mfma_f32_16x16x32_bf16 v[8:11], a[76:79], a[16:19], v[8:11]
    v_add3_u32 v115, v3, v2, s68
    v_mfma_f32_16x16x32_bf16 v[12:15], a[76:79], a[12:15], v[12:15]
    s_movk_i32 s56, 4608
    v_mfma_f32_16x16x32_bf16 v[16:19], a[76:79], a[8:11], v[16:19]
    v_mfma_f32_16x16x32_bf16 v[20:23], a[76:79], a[100:103], v[20:23]
    v_mfma_f32_16x16x32_bf16 v[24:27], a[76:79], a[104:107], v[24:27]
    v_mfma_f32_16x16x32_bf16 v[28:31], a[76:79], a[108:111], v[28:31]
    v_mfma_f32_16x16x32_bf16 v[32:35], a[76:79], a[112:115], v[32:35]
    v_mfma_f32_16x16x32_bf16 v[36:39], a[76:79], a[116:119], v[36:39]
    s_waitcnt lgkmcnt(4)
    v_mfma_f32_16x16x32_bf16 v[40:43], a[64:67], a[16:19], v[40:43]
    v_mfma_f32_16x16x32_bf16 v[44:47], a[64:67], a[12:15], v[44:47]
    v_mfma_f32_16x16x32_bf16 v[48:51], a[64:67], a[8:11], v[48:51]
    v_mfma_f32_16x16x32_bf16 v[52:55], a[64:67], a[100:103], v[52:55]
    v_mfma_f32_16x16x32_bf16 v[56:59], a[64:67], a[104:107], v[56:59]
    v_mfma_f32_16x16x32_bf16 v[60:63], a[64:67], a[108:111], v[60:63]
    v_mfma_f32_16x16x32_bf16 v[64:67], a[64:67], a[112:115], v[64:67]
    v_mfma_f32_16x16x32_bf16 v[68:71], a[64:67], a[116:119], v[68:71]
    s_waitcnt vmcnt(5) lgkmcnt(0)
    s_barrier
    s_setprio 3
    s_add_u32 m0, s43, 18432
    s_movk_i32 s30, 128
    buffer_load_dwordx4 v104, s[12:15], s30 offen lds
    s_setprio 1
    v_mfma_f32_16x16x32_bf16 v[8:11], a[80:83], a[20:23], v[8:11]
    ds_read_b64_tr_b16 a[88:89], v91 offset:36864
    v_mfma_f32_16x16x32_bf16 v[12:15], a[80:83], a[16:19], v[12:15]
    ds_read_b64_tr_b16 a[90:91], v91 offset:39168
    v_mfma_f32_16x16x32_bf16 v[16:19], a[80:83], a[12:15], v[16:19]
    ds_read_b128 a[72:75], v99 offset:9472
    v_mfma_f32_16x16x32_bf16 v[20:23], a[80:83], a[8:11], v[20:23]
    ds_read_b128 a[84:87], v99 offset:9600
    v_mfma_f32_16x16x32_bf16 v[24:27], a[80:83], a[100:103], v[24:27]
    ds_read_b128 a[40:43], v99 offset:9728
    v_mfma_f32_16x16x32_bf16 v[28:31], a[80:83], a[104:107], v[28:31]
    ds_read_b128 a[44:47], v99 offset:9856
    v_mfma_f32_16x16x32_bf16 v[32:35], a[80:83], a[108:111], v[32:35]
    ds_read_b128 a[48:51], v99 offset:10016
    v_mfma_f32_16x16x32_bf16 v[36:39], a[80:83], a[112:115], v[36:39]
    ds_read_b128 a[52:55], v99 offset:10144
    v_mfma_f32_16x16x32_bf16 v[40:43], a[68:71], a[20:23], v[40:43]
    ds_read_b128 a[56:59], v99 offset:10272
    v_mfma_f32_16x16x32_bf16 v[44:47], a[68:71], a[16:19], v[44:47]
    ds_read_b128 a[92:95], v99 offset:10400
    v_mfma_f32_16x16x32_bf16 v[48:51], a[68:71], a[12:15], v[48:51]
    ds_read_b64_tr_b16 a[60:61], v92 offset:36864
    v_mfma_f32_16x16x32_bf16 v[52:55], a[68:71], a[8:11], v[52:55]
    ds_read_b64_tr_b16 a[62:63], v92 offset:39168
    v_mfma_f32_16x16x32_bf16 v[56:59], a[68:71], a[100:103], v[56:59]
    ds_read_b64_tr_b16 a[96:97], v95 offset:0
    v_mfma_f32_16x16x32_bf16 v[60:63], a[68:71], a[104:107], v[60:63]
    ds_read_b64_tr_b16 a[98:99], v95 offset:2304
    v_mfma_f32_16x16x32_bf16 v[64:67], a[68:71], a[108:111], v[64:67]
    ds_read_b64_tr_b16 a[4:5], v96 offset:0
    v_mfma_f32_16x16x32_bf16 v[68:71], a[68:71], a[112:115], v[68:71]
    s_waitcnt lgkmcnt(8)
    ds_read_b64_tr_b16 a[6:7], v96 offset:2304
    v_mfma_f32_16x16x32_bf16 v[8:11], a[88:91], a[72:75], v[8:11]
    ds_read_b128 a[0:3], v99 offset:9344
    v_mfma_f32_16x16x32_bf16 v[12:15], a[88:91], a[84:87], v[12:15]
    ds_read_b128 a[24:27], v99 offset:9216
    v_mfma_f32_16x16x32_bf16 v[16:19], a[88:91], a[40:43], v[16:19]
    ds_read_b128 a[28:31], v99 offset:9088
    v_mfma_f32_16x16x32_bf16 v[20:23], a[88:91], a[44:47], v[20:23]
    v_mfma_f32_16x16x32_bf16 v[24:27], a[88:91], a[48:51], v[24:27]
    ds_read_b128 a[124:127], v99 offset:8960
    s_waitcnt lgkmcnt(12)
    v_mfma_f32_16x16x32_bf16 v[28:31], a[88:91], a[52:55], v[28:31]
    s_waitcnt lgkmcnt(11)
    v_mfma_f32_16x16x32_bf16 v[32:35], a[88:91], a[56:59], v[32:35]
    s_waitcnt lgkmcnt(10)
    v_mfma_f32_16x16x32_bf16 v[36:39], a[88:91], a[92:95], v[36:39]
    s_waitcnt lgkmcnt(8)
    v_mfma_f32_16x16x32_bf16 v[40:43], a[60:63], a[72:75], v[40:43]
    v_mfma_f32_16x16x32_bf16 v[44:47], a[60:63], a[84:87], v[44:47]
    v_mfma_f32_16x16x32_bf16 v[48:51], a[60:63], a[40:43], v[48:51]
    v_mfma_f32_16x16x32_bf16 v[52:55], a[60:63], a[44:47], v[52:55]
    v_mfma_f32_16x16x32_bf16 v[56:59], a[60:63], a[48:51], v[56:59]
    v_mfma_f32_16x16x32_bf16 v[60:63], a[60:63], a[52:55], v[60:63]
    v_mfma_f32_16x16x32_bf16 v[64:67], a[60:63], a[56:59], v[64:67]
    v_mfma_f32_16x16x32_bf16 v[68:71], a[60:63], a[92:95], v[68:71]
    s_waitcnt vmcnt(1) lgkmcnt(4)
    s_barrier
    s_setprio 3
    s_add_u32 m0, s29, 18432
    s_add_u32 s30, s29, 36864
    s_mov_b32 exec_hi, 0
    buffer_load_dwordx4 v89, s[16:19], s30 offen lds
    s_mov_b32 exec_hi, -1
    buffer_load_dwordx4 v89, s[16:19], s30 offen offset:512 lds
    buffer_load_dwordx4 v89, s[16:19], s30 offen offset:1536 lds
    buffer_load_dwordx4 v89, s[16:19], s30 offen offset:2560 lds
    buffer_load_dwordx4 v89, s[16:19], s30 offen offset:3584 lds
    s_add_u32 m0, s29, 55296
    s_add_u32 s30, s29, 202752
    s_mov_b32 exec_hi, 0
    buffer_load_dwordx4 v89, s[16:19], s30 offen lds
    s_mov_b32 exec_hi, -1
    buffer_load_dwordx4 v89, s[16:19], s30 offen offset:512 lds
    buffer_load_dwordx4 v89, s[16:19], s30 offen offset:1536 lds
    buffer_load_dwordx4 v89, s[16:19], s30 offen offset:2560 lds
    buffer_load_dwordx4 v89, s[16:19], s30 offen offset:3584 lds
    s_setprio 1
    s_waitcnt lgkmcnt(3)
    v_mfma_f32_16x16x32_bf16 v[8:11], a[96:99], a[0:3], v[8:11]
    ds_read_b64_tr_b16 a[36:37], v95 offset:18432
    v_mfma_f32_16x16x32_bf16 v[12:15], a[96:99], a[72:75], v[12:15]
    ds_read_b64_tr_b16 a[38:39], v95 offset:20736
    v_mfma_f32_16x16x32_bf16 v[16:19], a[96:99], a[84:87], v[16:19]
    ds_read_b64_tr_b16 a[32:33], v96 offset:18432
    v_mfma_f32_16x16x32_bf16 v[20:23], a[96:99], a[40:43], v[20:23]
    ds_read_b64_tr_b16 a[34:35], v96 offset:20736
    v_mfma_f32_16x16x32_bf16 v[24:27], a[96:99], a[44:47], v[24:27]
    ds_read_b64_tr_b16 a[120:121], v95 offset:36864
    v_mfma_f32_16x16x32_bf16 v[28:31], a[96:99], a[48:51], v[28:31]
    ds_read_b64_tr_b16 a[122:123], v95 offset:39168
    v_mfma_f32_16x16x32_bf16 v[32:35], a[96:99], a[52:55], v[32:35]
    ds_read_b64_tr_b16 a[76:77], v96 offset:36864
    v_mfma_f32_16x16x32_bf16 v[36:39], a[96:99], a[56:59], v[36:39]
    ds_read_b64_tr_b16 a[78:79], v96 offset:39168
    v_mfma_f32_16x16x32_bf16 v[40:43], a[4:7], a[0:3], v[40:43]
    v_mfma_f32_16x16x32_bf16 v[44:47], a[4:7], a[72:75], v[44:47]
    v_mfma_f32_16x16x32_bf16 v[48:51], a[4:7], a[84:87], v[48:51]
    v_mfma_f32_16x16x32_bf16 v[52:55], a[4:7], a[40:43], v[52:55]
    v_mfma_f32_16x16x32_bf16 v[56:59], a[4:7], a[44:47], v[56:59]
    v_mfma_f32_16x16x32_bf16 v[60:63], a[4:7], a[48:51], v[60:63]
    v_mfma_f32_16x16x32_bf16 v[64:67], a[4:7], a[52:55], v[64:67]
    v_mfma_f32_16x16x32_bf16 v[68:71], a[4:7], a[56:59], v[68:71]
    s_waitcnt lgkmcnt(6)
    v_mfma_f32_16x16x32_bf16 v[8:11], a[36:39], a[24:27], v[8:11]
    v_mfma_f32_16x16x32_bf16 v[12:15], a[36:39], a[0:3], v[12:15]
    v_mfma_f32_16x16x32_bf16 v[16:19], a[36:39], a[72:75], v[16:19]
    v_mfma_f32_16x16x32_bf16 v[20:23], a[36:39], a[84:87], v[20:23]
    v_mfma_f32_16x16x32_bf16 v[24:27], a[36:39], a[40:43], v[24:27]
    v_mfma_f32_16x16x32_bf16 v[28:31], a[36:39], a[44:47], v[28:31]
    v_mfma_f32_16x16x32_bf16 v[32:35], a[36:39], a[48:51], v[32:35]
    v_mfma_f32_16x16x32_bf16 v[36:39], a[36:39], a[52:55], v[36:39]
    s_waitcnt lgkmcnt(4)
    v_mfma_f32_16x16x32_bf16 v[40:43], a[32:35], a[24:27], v[40:43]
    v_mfma_f32_16x16x32_bf16 v[44:47], a[32:35], a[0:3], v[44:47]
    v_mfma_f32_16x16x32_bf16 v[48:51], a[32:35], a[72:75], v[48:51]
    v_mfma_f32_16x16x32_bf16 v[52:55], a[32:35], a[84:87], v[52:55]
    v_mfma_f32_16x16x32_bf16 v[56:59], a[32:35], a[40:43], v[56:59]
    v_mfma_f32_16x16x32_bf16 v[60:63], a[32:35], a[44:47], v[60:63]
    v_mfma_f32_16x16x32_bf16 v[64:67], a[32:35], a[48:51], v[64:67]
    v_mfma_f32_16x16x32_bf16 v[68:71], a[32:35], a[52:55], v[68:71]
    s_waitcnt vmcnt(5) lgkmcnt(0)
    s_barrier
    s_setprio 3
    s_lshl_b32 s30, s70, 2
    s_add_u32 s30, s30, s3
    s_mul_i32 s30, s30, 384
    s_sub_u32 s30, s30, 1536
    v_lshl_add_u32 v6, v88, 7, s30
    s_mov_b64 exec, 7
    buffer_load_dword v5, v6, s[20:23], 0 offen
    s_mov_b64 exec, -1
    s_mul_i32 s30, s3, 576
    s_add_u32 m0, s30, 152064
    s_add_u32 s30, s30, 36864
    s_mov_b32 exec_hi, 15
    buffer_load_dwordx4 v90, s[20:23], s30 offen lds
    s_mov_b32 exec_hi, -1
    s_add_u32 m0, s29, 92160
    s_add_u32 s30, s29, 368640
    s_mov_b32 exec_hi, 0
    buffer_load_dwordx4 v89, s[16:19], s30 offen lds
    s_mov_b32 exec_hi, -1
    buffer_load_dwordx4 v89, s[16:19], s30 offen offset:512 lds
    buffer_load_dwordx4 v89, s[16:19], s30 offen offset:1536 lds
    buffer_load_dwordx4 v89, s[16:19], s30 offen offset:2560 lds
    buffer_load_dwordx4 v89, s[16:19], s30 offen offset:3584 lds
    s_setprio 1
    v_mfma_f32_16x16x32_bf16 v[8:11], a[120:123], a[28:31], v[8:11]
    ds_read_b64_tr_b16 a[64:65], v91 offset:0
    v_mfma_f32_16x16x32_bf16 v[12:15], a[120:123], a[24:27], v[12:15]
    ds_read_b64_tr_b16 a[66:67], v91 offset:2304
    v_mfma_f32_16x16x32_bf16 v[16:19], a[120:123], a[0:3], v[16:19]
    ds_read_b64_tr_b16 a[116:117], v92 offset:0
    v_mfma_f32_16x16x32_bf16 v[20:23], a[120:123], a[72:75], v[20:23]
    ds_read_b64_tr_b16 a[118:119], v92 offset:2304
    v_mfma_f32_16x16x32_bf16 v[24:27], a[120:123], a[84:87], v[24:27]
    ds_read_b64_tr_b16 a[80:81], v91 offset:18432
    v_mfma_f32_16x16x32_bf16 v[28:31], a[120:123], a[40:43], v[28:31]
    ds_read_b64_tr_b16 a[82:83], v91 offset:20736
    v_mfma_f32_16x16x32_bf16 v[32:35], a[120:123], a[44:47], v[32:35]
    ds_read_b64_tr_b16 a[20:21], v92 offset:18432
    v_mfma_f32_16x16x32_bf16 v[36:39], a[120:123], a[48:51], v[36:39]
    ds_read_b64_tr_b16 a[22:23], v92 offset:20736
    v_mfma_f32_16x16x32_bf16 v[40:43], a[76:79], a[28:31], v[40:43]
    ds_read_b128 a[16:19], v99 offset:18944
    v_mfma_f32_16x16x32_bf16 v[44:47], a[76:79], a[24:27], v[44:47]
    ds_read_b128 a[12:15], v99 offset:19072
    v_mfma_f32_16x16x32_bf16 v[48:51], a[76:79], a[0:3], v[48:51]
    ds_read_b128 a[8:11], v99 offset:19200
    v_mfma_f32_16x16x32_bf16 v[52:55], a[76:79], a[72:75], v[52:55]
    ds_read_b128 a[100:103], v99 offset:19328
    v_mfma_f32_16x16x32_bf16 v[56:59], a[76:79], a[84:87], v[56:59]
    ds_read_b128 a[104:107], v99 offset:19488
    v_mfma_f32_16x16x32_bf16 v[60:63], a[76:79], a[40:43], v[60:63]
    ds_read_b128 a[108:111], v99 offset:19616
    v_mfma_f32_16x16x32_bf16 v[64:67], a[76:79], a[44:47], v[64:67]
    ds_read_b128 a[68:71], v99 offset:19744
    v_mfma_f32_16x16x32_bf16 v[68:71], a[76:79], a[48:51], v[68:71]
    s_waitcnt lgkmcnt(8)
    ds_read_b128 a[112:115], v99 offset:19872
    v_mfma_f32_16x16x32_bf16 v[8:11], a[64:67], a[124:127], v[8:11]
    ds_read_b128 a[88:91], v99 offset:18816
    v_mfma_f32_16x16x32_bf16 v[12:15], a[64:67], a[28:31], v[12:15]
    ds_read_b128 a[60:63], v99 offset:18688
    v_mfma_f32_16x16x32_bf16 v[16:19], a[64:67], a[24:27], v[16:19]
    v_mfma_f32_16x16x32_bf16 v[20:23], a[64:67], a[0:3], v[20:23]
    v_mfma_f32_16x16x32_bf16 v[24:27], a[64:67], a[72:75], v[24:27]
    ds_read_b128 a[92:95], v99 offset:18560
    v_mfma_f32_16x16x32_bf16 v[28:31], a[64:67], a[84:87], v[28:31]
    v_mfma_f32_16x16x32_bf16 v[32:35], a[64:67], a[40:43], v[32:35]
    v_mfma_f32_16x16x32_bf16 v[36:39], a[64:67], a[44:47], v[36:39]
    v_mfma_f32_16x16x32_bf16 v[40:43], a[116:119], a[124:127], v[40:43]
    v_mfma_f32_16x16x32_bf16 v[44:47], a[116:119], a[28:31], v[44:47]
    v_mfma_f32_16x16x32_bf16 v[48:51], a[116:119], a[24:27], v[48:51]
    v_mfma_f32_16x16x32_bf16 v[52:55], a[116:119], a[0:3], v[52:55]
    v_mfma_f32_16x16x32_bf16 v[56:59], a[116:119], a[72:75], v[56:59]
    v_mfma_f32_16x16x32_bf16 v[60:63], a[116:119], a[84:87], v[60:63]
    v_mfma_f32_16x16x32_bf16 v[64:67], a[116:119], a[40:43], v[64:67]
    v_mfma_f32_16x16x32_bf16 v[68:71], a[116:119], a[44:47], v[68:71]
    s_waitcnt vmcnt(7) lgkmcnt(11)
    s_barrier
    s_setprio 3
    s_add_u32 m0, s43, 27392
    s_movk_i32 s30, 192
    buffer_load_dwordx4 v104, s[12:15], s30 offen lds
    s_add_u32 m0, s29, 18432
    s_add_u32 s30, s29, 138240
    s_mov_b32 exec_hi, 0
    buffer_load_dwordx4 v89, s[16:19], s30 offen lds
    s_mov_b32 exec_hi, -1
    buffer_load_dwordx4 v89, s[16:19], s30 offen offset:512 lds
    buffer_load_dwordx4 v89, s[16:19], s30 offen offset:1536 lds
    buffer_load_dwordx4 v89, s[16:19], s30 offen offset:2560 lds
    buffer_load_dwordx4 v89, s[16:19], s30 offen offset:3584 lds
    s_setprio 1
    s_waitcnt lgkmcnt(10)
    v_mfma_f32_16x16x32_bf16 v[8:11], a[80:83], a[16:19], v[8:11]
    ds_read_b64_tr_b16 a[96:97], v91 offset:36864
    s_waitcnt lgkmcnt(10)
    v_mfma_f32_16x16x32_bf16 v[12:15], a[80:83], a[12:15], v[12:15]
    ds_read_b64_tr_b16 a[98:99], v91 offset:39168
    s_waitcnt lgkmcnt(10)
    v_mfma_f32_16x16x32_bf16 v[16:19], a[80:83], a[8:11], v[16:19]
    ds_read_b64_tr_b16 a[4:5], v92 offset:36864
    s_waitcnt lgkmcnt(10)
    v_mfma_f32_16x16x32_bf16 v[20:23], a[80:83], a[100:103], v[20:23]
    ds_read_b64_tr_b16 a[6:7], v92 offset:39168
    s_waitcnt lgkmcnt(10)
    v_mfma_f32_16x16x32_bf16 v[24:27], a[80:83], a[104:107], v[24:27]
    ds_read_b64_tr_b16 a[56:57], v95 offset:0
    s_waitcnt lgkmcnt(10)
    v_mfma_f32_16x16x32_bf16 v[28:31], a[80:83], a[108:111], v[28:31]
    ds_read_b64_tr_b16 a[58:59], v95 offset:2304
    s_waitcnt lgkmcnt(10)
    v_mfma_f32_16x16x32_bf16 v[32:35], a[80:83], a[68:71], v[32:35]
    ds_read_b64_tr_b16 a[36:37], v96 offset:0
    s_waitcnt lgkmcnt(10)
    v_mfma_f32_16x16x32_bf16 v[36:39], a[80:83], a[112:115], v[36:39]
    ds_read_b64_tr_b16 a[38:39], v96 offset:2304
    v_mfma_f32_16x16x32_bf16 v[40:43], a[20:23], a[16:19], v[40:43]
    ds_read_b128 a[32:35], v99 offset:18432
    v_mfma_f32_16x16x32_bf16 v[44:47], a[20:23], a[12:15], v[44:47]
    v_mfma_f32_16x16x32_bf16 v[48:51], a[20:23], a[8:11], v[48:51]
    v_mfma_f32_16x16x32_bf16 v[52:55], a[20:23], a[100:103], v[52:55]
    v_mfma_f32_16x16x32_bf16 v[56:59], a[20:23], a[104:107], v[56:59]
    v_mfma_f32_16x16x32_bf16 v[60:63], a[20:23], a[108:111], v[60:63]
    v_mfma_f32_16x16x32_bf16 v[64:67], a[20:23], a[68:71], v[64:67]
    v_mfma_f32_16x16x32_bf16 v[68:71], a[20:23], a[112:115], v[68:71]
    s_waitcnt lgkmcnt(7)
    v_mfma_f32_16x16x32_bf16 v[8:11], a[96:99], a[88:91], v[8:11]
    v_mfma_f32_16x16x32_bf16 v[12:15], a[96:99], a[16:19], v[12:15]
    v_mfma_f32_16x16x32_bf16 v[16:19], a[96:99], a[12:15], v[16:19]
    v_mfma_f32_16x16x32_bf16 v[20:23], a[96:99], a[8:11], v[20:23]
    v_mfma_f32_16x16x32_bf16 v[24:27], a[96:99], a[100:103], v[24:27]
    v_mfma_f32_16x16x32_bf16 v[28:31], a[96:99], a[104:107], v[28:31]
    v_mfma_f32_16x16x32_bf16 v[32:35], a[96:99], a[108:111], v[32:35]
    v_mfma_f32_16x16x32_bf16 v[36:39], a[96:99], a[68:71], v[36:39]
    s_waitcnt vmcnt(6) lgkmcnt(1)
    s_barrier
    s_setprio 3
    s_add_u32 m0, s29, 36864
    s_add_u32 s30, s29, 221184
    s_mov_b32 exec_hi, 0
    buffer_load_dwordx4 v89, s[16:19], s30 offen lds
    s_mov_b32 exec_hi, -1
    buffer_load_dwordx4 v89, s[16:19], s30 offen offset:512 lds
    buffer_load_dwordx4 v89, s[16:19], s30 offen offset:1536 lds
    buffer_load_dwordx4 v89, s[16:19], s30 offen offset:2560 lds
    buffer_load_dwordx4 v89, s[16:19], s30 offen offset:3584 lds
    s_setprio 1
    v_mfma_f32_16x16x32_bf16 v[40:43], a[4:7], a[88:91], v[40:43]
    ds_read_b64_tr_b16 a[52:53], v95 offset:18432
    v_mfma_f32_16x16x32_bf16 v[44:47], a[4:7], a[16:19], v[44:47]
    ds_read_b64_tr_b16 a[54:55], v95 offset:20736
    v_mfma_f32_16x16x32_bf16 v[48:51], a[4:7], a[12:15], v[48:51]
    ds_read_b64_tr_b16 a[120:121], v96 offset:18432
    v_mfma_f32_16x16x32_bf16 v[52:55], a[4:7], a[8:11], v[52:55]
    ds_read_b64_tr_b16 a[122:123], v96 offset:20736
    v_mfma_f32_16x16x32_bf16 v[56:59], a[4:7], a[100:103], v[56:59]
    ds_read_b64_tr_b16 a[76:77], v95 offset:36864
    v_mfma_f32_16x16x32_bf16 v[60:63], a[4:7], a[104:107], v[60:63]
    ds_read_b64_tr_b16 a[78:79], v95 offset:39168
    v_mfma_f32_16x16x32_bf16 v[64:67], a[4:7], a[108:111], v[64:67]
    ds_read_b64_tr_b16 a[48:49], v96 offset:36864
    v_mfma_f32_16x16x32_bf16 v[68:71], a[4:7], a[68:71], v[68:71]
    ds_read_b64_tr_b16 a[50:51], v96 offset:39168
    v_mfma_f32_16x16x32_bf16 v[8:11], a[56:59], a[60:63], v[8:11]
    v_mfma_f32_16x16x32_bf16 v[12:15], a[56:59], a[88:91], v[12:15]
    v_mfma_f32_16x16x32_bf16 v[16:19], a[56:59], a[16:19], v[16:19]
    v_mfma_f32_16x16x32_bf16 v[20:23], a[56:59], a[12:15], v[20:23]
    v_mfma_f32_16x16x32_bf16 v[24:27], a[56:59], a[8:11], v[24:27]
    v_mfma_f32_16x16x32_bf16 v[28:31], a[56:59], a[100:103], v[28:31]
    v_mfma_f32_16x16x32_bf16 v[32:35], a[56:59], a[104:107], v[32:35]
    v_mfma_f32_16x16x32_bf16 v[36:39], a[56:59], a[108:111], v[36:39]
    v_mfma_f32_16x16x32_bf16 v[40:43], a[36:39], a[60:63], v[40:43]
    v_mfma_f32_16x16x32_bf16 v[44:47], a[36:39], a[88:91], v[44:47]
    v_mfma_f32_16x16x32_bf16 v[48:51], a[36:39], a[16:19], v[48:51]
    v_mfma_f32_16x16x32_bf16 v[52:55], a[36:39], a[12:15], v[52:55]
    v_mfma_f32_16x16x32_bf16 v[56:59], a[36:39], a[8:11], v[56:59]
    v_mfma_f32_16x16x32_bf16 v[60:63], a[36:39], a[100:103], v[60:63]
    v_mfma_f32_16x16x32_bf16 v[64:67], a[36:39], a[104:107], v[64:67]
    v_mfma_f32_16x16x32_bf16 v[68:71], a[36:39], a[108:111], v[68:71]
    s_waitcnt vmcnt(5) lgkmcnt(0)
    s_barrier
    s_setprio 3
    s_add_u32 m0, s29, 73728
    s_add_u32 s30, s29, 387072
    s_mov_b32 exec_hi, 0
    buffer_load_dwordx4 v89, s[16:19], s30 offen lds
    s_mov_b32 exec_hi, -1
    buffer_load_dwordx4 v89, s[16:19], s30 offen offset:512 lds
    buffer_load_dwordx4 v89, s[16:19], s30 offen offset:1536 lds
    buffer_load_dwordx4 v89, s[16:19], s30 offen offset:2560 lds
    buffer_load_dwordx4 v89, s[16:19], s30 offen offset:3584 lds
    s_setprio 1
    v_mfma_f32_16x16x32_bf16 v[8:11], a[52:55], a[92:95], v[8:11]
    ds_read_b64_tr_b16 a[64:65], v91 offset:0
    v_mfma_f32_16x16x32_bf16 v[12:15], a[52:55], a[60:63], v[12:15]
    ds_read_b64_tr_b16 a[66:67], v91 offset:2304
    v_mfma_f32_16x16x32_bf16 v[16:19], a[52:55], a[88:91], v[16:19]
    ds_read_b64_tr_b16 a[124:125], v91 offset:18432
    v_mfma_f32_16x16x32_bf16 v[20:23], a[52:55], a[16:19], v[20:23]
    ds_read_b64_tr_b16 a[126:127], v91 offset:20736
    v_mfma_f32_16x16x32_bf16 v[24:27], a[52:55], a[12:15], v[24:27]
    ds_read_b64_tr_b16 a[28:29], v92 offset:0
    v_mfma_f32_16x16x32_bf16 v[28:31], a[52:55], a[8:11], v[28:31]
    ds_read_b64_tr_b16 a[30:31], v92 offset:2304
    v_mfma_f32_16x16x32_bf16 v[32:35], a[52:55], a[100:103], v[32:35]
    ds_read_b64_tr_b16 a[24:25], v92 offset:18432
    v_mfma_f32_16x16x32_bf16 v[36:39], a[52:55], a[104:107], v[36:39]
    ds_read_b64_tr_b16 a[26:27], v92 offset:20736
    v_mfma_f32_16x16x32_bf16 v[40:43], a[120:123], a[92:95], v[40:43]
    ds_read_b128 a[0:3], v99 offset:27904
    v_mfma_f32_16x16x32_bf16 v[44:47], a[120:123], a[60:63], v[44:47]
    ds_read_b128 a[72:75], v99 offset:27776
    v_mfma_f32_16x16x32_bf16 v[48:51], a[120:123], a[88:91], v[48:51]
    ds_read_b128 a[84:87], v99 offset:27648
    v_mfma_f32_16x16x32_bf16 v[52:55], a[120:123], a[16:19], v[52:55]
    ds_read_b128 a[40:43], v99 offset:27520
    v_mfma_f32_16x16x32_bf16 v[56:59], a[120:123], a[12:15], v[56:59]
    ds_read_b128 a[116:119], v99 offset:27392
    v_mfma_f32_16x16x32_bf16 v[60:63], a[120:123], a[8:11], v[60:63]
    ds_read_b128 a[44:47], v99 offset:28032
    v_mfma_f32_16x16x32_bf16 v[64:67], a[120:123], a[100:103], v[64:67]
    ds_read_b128 a[80:83], v99 offset:28160
    v_mfma_f32_16x16x32_bf16 v[68:71], a[120:123], a[104:107], v[68:71]
    s_waitcnt lgkmcnt(8)
    ds_read_b128 a[20:23], v99 offset:28288
    v_mfma_f32_16x16x32_bf16 v[8:11], a[76:79], a[32:35], v[8:11]
    ds_read_b128 a[112:115], v99 offset:28448
    v_mfma_f32_16x16x32_bf16 v[12:15], a[76:79], a[92:95], v[12:15]
    v_mfma_f32_16x16x32_bf16 v[16:19], a[76:79], a[60:63], v[16:19]
    v_mfma_f32_16x16x32_bf16 v[20:23], a[76:79], a[88:91], v[20:23]
    v_mfma_f32_16x16x32_bf16 v[24:27], a[76:79], a[16:19], v[24:27]
    s_waitcnt vmcnt(0) lgkmcnt(9)
    s_barrier
    s_setprio 3
    s_add_u32 m0, s29, 92160
    s_add_u32 s30, s29, 18432
    s_mov_b32 exec_hi, 0
    buffer_load_dwordx4 v90, s[20:23], s30 offen lds
    s_mov_b32 exec_hi, -1
    buffer_load_dwordx4 v90, s[20:23], s30 offen offset:512 lds
    buffer_load_dwordx4 v90, s[20:23], s30 offen offset:1536 lds
    buffer_load_dwordx4 v90, s[20:23], s30 offen offset:2560 lds
    buffer_load_dwordx4 v90, s[20:23], s30 offen offset:3584 lds
    s_setprio 1
    v_mfma_f32_16x16x32_bf16 v[28:31], a[76:79], a[12:15], v[28:31]
    ds_read_b64_tr_b16 a[96:97], v91 offset:36864
    v_mfma_f32_16x16x32_bf16 v[32:35], a[76:79], a[8:11], v[32:35]
    ds_read_b64_tr_b16 a[98:99], v91 offset:39168
    v_mfma_f32_16x16x32_bf16 v[36:39], a[76:79], a[100:103], v[36:39]
    ds_read_b64_tr_b16 a[4:5], v95 offset:0
    v_mfma_f32_16x16x32_bf16 v[40:43], a[48:51], a[32:35], v[40:43]
    ds_read_b64_tr_b16 a[6:7], v95 offset:2304
    v_mfma_f32_16x16x32_bf16 v[44:47], a[48:51], a[92:95], v[44:47]
    ds_read_b64_tr_b16 a[68:69], v95 offset:18432
    v_mfma_f32_16x16x32_bf16 v[48:51], a[48:51], a[60:63], v[48:51]
    ds_read_b64_tr_b16 a[70:71], v95 offset:20736
    v_mfma_f32_16x16x32_bf16 v[52:55], a[48:51], a[88:91], v[52:55]
    s_waitcnt lgkmcnt(8)
    ds_read_b64_tr_b16 a[56:57], v92 offset:36864
    v_mfma_f32_16x16x32_bf16 v[56:59], a[48:51], a[16:19], v[56:59]
    ds_read_b64_tr_b16 a[58:59], v92 offset:39168
    v_mfma_f32_16x16x32_bf16 v[60:63], a[48:51], a[12:15], v[60:63]
    ds_read_b64_tr_b16 a[36:37], v96 offset:0
    v_mfma_f32_16x16x32_bf16 v[64:67], a[48:51], a[8:11], v[64:67]
    ds_read_b64_tr_b16 a[38:39], v96 offset:2304
    v_mfma_f32_16x16x32_bf16 v[68:71], a[48:51], a[100:103], v[68:71]
    ds_read_b64_tr_b16 a[108:109], v96 offset:18432
    v_mfma_f32_16x16x32_bf16 v[8:11], a[64:67], a[0:3], v[8:11]
    ds_read_b64_tr_b16 a[110:111], v96 offset:20736
    v_mfma_f32_16x16x32_bf16 v[8:11], a[124:127], a[72:75], v[8:11]
    ds_read_b128 a[52:55], v99 offset:28576
    s_waitcnt lgkmcnt(11)
    v_mfma_f32_16x16x32_bf16 v[8:11], a[96:99], a[84:87], v[8:11]
    ds_read_b128 a[120:123], v99 offset:28704
    s_waitcnt lgkmcnt(10)
    v_mfma_f32_16x16x32_bf16 v[8:11], a[4:7], a[40:43], v[8:11]
    s_waitcnt lgkmcnt(8)
    v_mfma_f32_16x16x32_bf16 v[8:11], a[68:71], a[116:119], v[8:11]
    v_mfma_f32_16x16x32_bf16 v[40:43], a[28:31], a[0:3], v[40:43]
    v_mfma_f32_16x16x32_bf16 v[40:43], a[24:27], a[72:75], v[40:43]
    s_waitcnt lgkmcnt(6)
    v_mfma_f32_16x16x32_bf16 v[40:43], a[56:59], a[84:87], v[40:43]
    s_waitcnt lgkmcnt(4)
    v_mfma_f32_16x16x32_bf16 v[40:43], a[36:39], a[40:43], v[40:43]
    s_waitcnt lgkmcnt(2)
    v_mfma_f32_16x16x32_bf16 v[40:43], a[108:111], a[116:119], v[40:43]
    v_mfma_f32_16x16x32_bf16 v[12:15], a[64:67], a[44:47], v[12:15]
    ds_read_b128 a[104:107], v99 offset:28832
    v_mfma_f32_16x16x32_bf16 v[12:15], a[124:127], a[0:3], v[12:15]
    v_mfma_f32_16x16x32_bf16 v[12:15], a[96:99], a[72:75], v[12:15]
    v_mfma_f32_16x16x32_bf16 v[12:15], a[4:7], a[84:87], v[12:15]
    v_mfma_f32_16x16x32_bf16 v[12:15], a[68:71], a[40:43], v[12:15]
    v_mfma_f32_16x16x32_bf16 v[44:47], a[28:31], a[44:47], v[44:47]
    v_mfma_f32_16x16x32_bf16 v[44:47], a[24:27], a[0:3], v[44:47]
    v_mfma_f32_16x16x32_bf16 v[44:47], a[56:59], a[72:75], v[44:47]
    v_mfma_f32_16x16x32_bf16 v[44:47], a[36:39], a[84:87], v[44:47]
    v_mfma_f32_16x16x32_bf16 v[44:47], a[108:111], a[40:43], v[44:47]
    v_mfma_f32_16x16x32_bf16 v[16:19], a[64:67], a[80:83], v[16:19]
    v_mfma_f32_16x16x32_bf16 v[16:19], a[124:127], a[44:47], v[16:19]
    v_mfma_f32_16x16x32_bf16 v[16:19], a[96:99], a[0:3], v[16:19]
    v_mfma_f32_16x16x32_bf16 v[16:19], a[4:7], a[72:75], v[16:19]
    v_mul_f32 v8, s52, v8
    v_mul_f32 v9, s52, v9
    v_mfma_f32_16x16x32_bf16 v[16:19], a[68:71], a[84:87], v[16:19]
    v_mul_f32 v10, s52, v10
    v_mul_f32 v11, s52, v11
    v_mfma_f32_16x16x32_bf16 v[48:51], a[28:31], a[80:83], v[48:51]
    v_mul_f32 v12, s52, v12
    v_mul_f32 v13, s52, v13
    v_mfma_f32_16x16x32_bf16 v[48:51], a[24:27], a[44:47], v[48:51]
    v_mul_f32 v14, s52, v14
    v_mul_f32 v15, s52, v15
    v_mfma_f32_16x16x32_bf16 v[48:51], a[56:59], a[0:3], v[48:51]
    v_mul_f32 v40, s32, v40
    v_mul_f32 v41, s32, v41
    v_mfma_f32_16x16x32_bf16 v[48:51], a[36:39], a[72:75], v[48:51]
    v_mul_f32 v42, s32, v42
    v_mul_f32 v43, s32, v43
    v_mfma_f32_16x16x32_bf16 v[48:51], a[108:111], a[84:87], v[48:51]
    v_mul_f32 v44, s32, v44
    v_mul_f32 v45, s32, v45
    v_mfma_f32_16x16x32_bf16 v[20:23], a[64:67], a[20:23], v[20:23]
    v_mul_f32 v46, s32, v46
    v_mul_f32 v47, s32, v47
    v_mfma_f32_16x16x32_bf16 v[20:23], a[124:127], a[80:83], v[20:23]
    v_exp_f32 v8, v8
    v_mfma_f32_16x16x32_bf16 v[20:23], a[96:99], a[44:47], v[20:23]
    v_exp_f32 v9, v9
    v_mfma_f32_16x16x32_bf16 v[20:23], a[4:7], a[0:3], v[20:23]
    v_exp_f32 v10, v10
    v_mfma_f32_16x16x32_bf16 v[20:23], a[68:71], a[72:75], v[20:23]
    v_exp_f32 v11, v11
    v_mfma_f32_16x16x32_bf16 v[52:55], a[28:31], a[20:23], v[52:55]
    v_exp_f32 v12, v12
    v_mfma_f32_16x16x32_bf16 v[52:55], a[24:27], a[80:83], v[52:55]
    v_exp_f32 v13, v13
    v_mfma_f32_16x16x32_bf16 v[52:55], a[56:59], a[44:47], v[52:55]
    v_exp_f32 v14, v14
    v_mfma_f32_16x16x32_bf16 v[52:55], a[36:39], a[0:3], v[52:55]
    v_exp_f32 v15, v15
    v_mfma_f32_16x16x32_bf16 v[52:55], a[108:111], a[72:75], v[52:55]
    v_exp_f32 v40, v40
    s_waitcnt vmcnt(0)
    s_barrier
    v_mfma_f32_16x16x32_bf16 v[24:27], a[64:67], a[112:115], v[24:27]
    v_exp_f32 v41, v41
    ds_read_b64_tr_b16 a[76:77], v105 offset:18432
    v_mfma_f32_16x16x32_bf16 v[24:27], a[124:127], a[20:23], v[24:27]
    v_exp_f32 v42, v42
    ds_read_b64_tr_b16 a[78:79], v105 offset:23040
    v_mfma_f32_16x16x32_bf16 v[24:27], a[96:99], a[80:83], v[24:27]
    v_exp_f32 v43, v43
    ds_read_b64_tr_b16 a[32:33], v105 offset:27648
    v_mfma_f32_16x16x32_bf16 v[24:27], a[4:7], a[44:47], v[24:27]
    v_exp_f32 v44, v44
    ds_read_b64_tr_b16 a[34:35], v105 offset:32256
    v_mfma_f32_16x16x32_bf16 v[24:27], a[68:71], a[0:3], v[24:27]
    v_exp_f32 v45, v45
    ds_read_b64_tr_b16 a[92:93], v105 offset:0
    v_mfma_f32_16x16x32_bf16 v[56:59], a[28:31], a[112:115], v[56:59]
    v_exp_f32 v46, v46
    ds_read_b64_tr_b16 a[94:95], v105 offset:4608
    v_mfma_f32_16x16x32_bf16 v[56:59], a[24:27], a[20:23], v[56:59]
    v_exp_f32 v47, v47
    ds_read_b64_tr_b16 a[60:61], v105 offset:9216
    v_mfma_f32_16x16x32_bf16 v[56:59], a[56:59], a[80:83], v[56:59]
    v_fma_f32 v8, v8, s34, s34 clamp
    v_fma_f32 v9, v9, s34, s34 clamp
    ds_read_b64_tr_b16 a[62:63], v105 offset:13824
    v_mfma_f32_16x16x32_bf16 v[56:59], a[36:39], a[44:47], v[56:59]
    v_fma_f32 v10, v10, s34, s34 clamp
    v_fma_f32 v11, v11, s34, s34 clamp
    ds_read_b64_tr_b16 a[88:89], v105 offset:59904
    v_mfma_f32_16x16x32_bf16 v[56:59], a[108:111], a[0:3], v[56:59]
    v_fma_f32 v12, v12, s34, s34 clamp
    v_fma_f32 v13, v13, s34, s34 clamp
    v_accvgpr_write_b32 a90, 0
    s_waitcnt lgkmcnt(11)
    v_mfma_f32_16x16x32_bf16 v[28:31], a[64:67], a[52:55], v[28:31]
    v_fma_f32 v14, v14, s34, s34 clamp
    v_fma_f32 v15, v15, s34, s34 clamp
    v_accvgpr_write_b32 a91, 0
    v_mfma_f32_16x16x32_bf16 v[28:31], a[124:127], a[112:115], v[28:31]
    v_fma_f32 v40, v8, v40, v8
    v_fma_f32 v41, v9, v41, v9
    ds_read_b64_tr_b16 a[16:17], v105 offset:18464
    v_mfma_f32_16x16x32_bf16 v[28:31], a[96:99], a[20:23], v[28:31]
    v_fma_f32 v42, v10, v42, v10
    v_fma_f32 v43, v11, v43, v11
    ds_read_b64_tr_b16 a[18:19], v105 offset:23072
    v_mfma_f32_16x16x32_bf16 v[28:31], a[4:7], a[80:83], v[28:31]
    v_fma_f32 v44, v12, v44, v12
    v_fma_f32 v45, v13, v45, v13
    ds_read_b64_tr_b16 a[12:13], v105 offset:27680
    v_mfma_f32_16x16x32_bf16 v[28:31], a[68:71], a[44:47], v[28:31]
    v_fma_f32 v46, v14, v46, v14
    v_fma_f32 v47, v15, v47, v15
    ds_read_b64_tr_b16 a[14:15], v105 offset:32288
    v_mfma_f32_16x16x32_bf16 v[60:63], a[28:31], a[52:55], v[60:63]
    v_rcp_f32 v40, v40
    s_waitcnt lgkmcnt(8)
    ds_read_b64_tr_b16 a[8:9], v105 offset:32
    v_mfma_f32_16x16x32_bf16 v[60:63], a[24:27], a[112:115], v[60:63]
    v_rcp_f32 v41, v41
    ds_read_b64_tr_b16 a[10:11], v105 offset:4640
    v_mfma_f32_16x16x32_bf16 v[60:63], a[56:59], a[20:23], v[60:63]
    v_rcp_f32 v42, v42
    ds_read_b64_tr_b16 a[48:49], v105 offset:9248
    v_mfma_f32_16x16x32_bf16 v[60:63], a[36:39], a[80:83], v[60:63]
    v_rcp_f32 v43, v43
    ds_read_b64_tr_b16 a[50:51], v105 offset:13856
    v_mfma_f32_16x16x32_bf16 v[60:63], a[108:111], a[44:47], v[60:63]
    v_rcp_f32 v44, v44
    ds_read_b64_tr_b16 a[100:101], v105 offset:59936
    v_mfma_f32_16x16x32_bf16 v[32:35], a[64:67], a[120:123], v[32:35]
    v_rcp_f32 v45, v45
    v_accvgpr_write_b32 a102, 0
    v_mfma_f32_16x16x32_bf16 v[32:35], a[124:127], a[52:55], v[32:35]
    v_rcp_f32 v46, v46
    v_accvgpr_write_b32 a103, 0
    v_mfma_f32_16x16x32_bf16 v[32:35], a[96:99], a[112:115], v[32:35]
    v_rcp_f32 v47, v47
    v_mfma_f32_16x16x32_bf16 v[32:35], a[4:7], a[20:23], v[32:35]
    v_sub_f32 v8, s54, v8
    v_sub_f32 v9, s54, v9
    v_mfma_f32_16x16x32_bf16 v[32:35], a[68:71], a[80:83], v[32:35]
    v_sub_f32 v10, s54, v10
    v_sub_f32 v11, s54, v11
    v_mfma_f32_16x16x32_bf16 v[64:67], a[28:31], a[120:123], v[64:67]
    v_sub_f32 v12, s54, v12
    v_sub_f32 v13, s54, v13
    v_mfma_f32_16x16x32_bf16 v[64:67], a[24:27], a[52:55], v[64:67]
    v_sub_f32 v14, s54, v14
    v_sub_f32 v15, s54, v15
    v_mfma_f32_16x16x32_bf16 v[64:67], a[56:59], a[112:115], v[64:67]
    v_mul_f32 v8, v8, v40
    v_mul_f32 v9, v9, v41
    v_mfma_f32_16x16x32_bf16 v[64:67], a[36:39], a[20:23], v[64:67]
    v_mul_f32 v10, v10, v42
    v_mul_f32 v11, v11, v43
    v_mfma_f32_16x16x32_bf16 v[64:67], a[108:111], a[80:83], v[64:67]
    v_mul_f32 v12, v12, v44
    v_mul_f32 v13, v13, v45
    v_mfma_f32_16x16x32_bf16 v[36:39], a[64:67], a[104:107], v[36:39]
    v_mul_f32 v14, v14, v46
    v_mul_f32 v15, v15, v47
    v_mfma_f32_16x16x32_bf16 v[36:39], a[124:127], a[120:123], v[36:39]
    v_cvt_pk_bf16_f32 v40, v8, v9
    v_cvt_pk_bf16_f32 v41, v10, v11
    v_mfma_f32_16x16x32_bf16 v[36:39], a[96:99], a[52:55], v[36:39]
    v_cvt_pk_bf16_f32 v44, v12, v13
    v_cvt_pk_bf16_f32 v45, v14, v15
    v_mfma_f32_16x16x32_bf16 v[36:39], a[4:7], a[112:115], v[36:39]
    ds_write2st64_b64 v107, v[40:41], v[44:45] offset0:0 offset1:2
    v_mfma_f32_16x16x32_bf16 v[36:39], a[68:71], a[20:23], v[36:39]
    v_mfma_f32_16x16x32_bf16 v[68:71], a[28:31], a[104:107], v[68:71]
    v_mfma_f32_16x16x32_bf16 v[68:71], a[24:27], a[120:123], v[68:71]
    v_mfma_f32_16x16x32_bf16 v[68:71], a[56:59], a[52:55], v[68:71]
    v_mfma_f32_16x16x32_bf16 v[68:71], a[36:39], a[112:115], v[68:71]
    v_mfma_f32_16x16x32_bf16 v[68:71], a[108:111], a[20:23], v[68:71]
    v_accvgpr_write_b32 a2, 0
    v_accvgpr_write_b32 a3, 0
    s_setprio 0
    v_pk_mul_f32 v[16:17], v[16:17], s[52:53]
    v_pk_mul_f32 v[18:19], v[18:19], s[52:53]
    v_pk_mul_f32 v[20:21], v[20:21], s[52:53]
    v_pk_mul_f32 v[22:23], v[22:23], s[52:53]
    v_pk_mul_f32 v[48:49], v[48:49], s[32:33]
    v_pk_mul_f32 v[50:51], v[50:51], s[32:33]
    v_pk_mul_f32 v[52:53], v[52:53], s[32:33]
    v_pk_mul_f32 v[54:55], v[54:55], s[32:33]
    s_waitcnt lgkmcnt(0)
    s_barrier
    v_exp_f32 v16, v16
    v_exp_f32 v17, v17
    v_exp_f32 v18, v18
    v_exp_f32 v19, v19
    v_exp_f32 v20, v20
    v_exp_f32 v21, v21
    v_exp_f32 v22, v22
    v_exp_f32 v23, v23
    v_exp_f32 v48, v48
    v_exp_f32 v49, v49
    v_exp_f32 v50, v50
    v_exp_f32 v51, v51
    v_exp_f32 v52, v52
    v_exp_f32 v53, v53
    v_exp_f32 v54, v54
    v_exp_f32 v55, v55
    v_pk_fma_f32 v[16:17], v[16:17], s[34:35], s[34:35] clamp
    v_pk_fma_f32 v[18:19], v[18:19], s[34:35], s[34:35] clamp
    v_pk_fma_f32 v[20:21], v[20:21], s[34:35], s[34:35] clamp
    v_pk_fma_f32 v[22:23], v[22:23], s[34:35], s[34:35] clamp
    v_pk_fma_f32 v[48:49], v[16:17], v[48:49], v[16:17]
    v_pk_fma_f32 v[50:51], v[18:19], v[50:51], v[18:19]
    v_pk_fma_f32 v[52:53], v[20:21], v[52:53], v[20:21]
    v_pk_fma_f32 v[54:55], v[22:23], v[54:55], v[22:23]
    v_rcp_f32 v48, v48
    v_rcp_f32 v49, v49
    v_rcp_f32 v50, v50
    v_rcp_f32 v51, v51
    v_rcp_f32 v52, v52
    v_rcp_f32 v53, v53
    v_rcp_f32 v54, v54
    v_rcp_f32 v55, v55
    v_pk_add_f32 v[16:17], s[54:55], v[16:17] neg_lo:[0,1] neg_hi:[0,1]
    v_pk_add_f32 v[18:19], s[54:55], v[18:19] neg_lo:[0,1] neg_hi:[0,1]
    v_pk_add_f32 v[20:21], s[54:55], v[20:21] neg_lo:[0,1] neg_hi:[0,1]
    v_pk_add_f32 v[22:23], s[54:55], v[22:23] neg_lo:[0,1] neg_hi:[0,1]
    v_pk_mul_f32 v[16:17], v[16:17], v[48:49]
    v_pk_mul_f32 v[18:19], v[18:19], v[50:51]
    v_pk_mul_f32 v[20:21], v[20:21], v[52:53]
    v_pk_mul_f32 v[22:23], v[22:23], v[54:55]
    v_cvt_pk_bf16_f32 v48, v16, v17
    v_cvt_pk_bf16_f32 v49, v18, v19
    v_cvt_pk_bf16_f32 v52, v20, v21
    v_cvt_pk_bf16_f32 v53, v22, v23
    ds_write2st64_b64 v107, v[48:49], v[52:53] offset0:4 offset1:6
    v_pk_mul_f32 v[24:25], v[24:25], s[52:53]
    v_pk_mul_f32 v[26:27], v[26:27], s[52:53]
    v_pk_mul_f32 v[28:29], v[28:29], s[52:53]
    v_pk_mul_f32 v[30:31], v[30:31], s[52:53]
    v_pk_mul_f32 v[56:57], v[56:57], s[32:33]
    v_pk_mul_f32 v[58:59], v[58:59], s[32:33]
    v_pk_mul_f32 v[60:61], v[60:61], s[32:33]
    v_pk_mul_f32 v[62:63], v[62:63], s[32:33]
    s_waitcnt lgkmcnt(0)
    s_barrier
    v_exp_f32 v24, v24
    v_exp_f32 v25, v25
    ds_read_b128 a[4:7], v112 offset:0
    v_exp_f32 v26, v26
    v_exp_f32 v27, v27
    ds_read_b128 a[68:71], v112 offset:1168
    v_exp_f32 v28, v28
    v_exp_f32 v29, v29
    ds_read_b128 a[28:31], v113 offset:1024
    v_exp_f32 v30, v30
    v_exp_f32 v31, v31
    v_exp_f32 v56, v56
    v_exp_f32 v57, v57
    v_exp_f32 v58, v58
    v_exp_f32 v59, v59
    v_exp_f32 v60, v60
    v_exp_f32 v61, v61
    v_exp_f32 v62, v62
    v_exp_f32 v63, v63
    s_waitcnt lgkmcnt(2)
    buffer_store_dwordx4 a[4:7], v114, s[24:27], 0 offen offset:0 sc0 sc1
    v_pk_fma_f32 v[24:25], v[24:25], s[34:35], s[34:35] clamp
    v_pk_fma_f32 v[26:27], v[26:27], s[34:35], s[34:35] clamp
    v_pk_fma_f32 v[28:29], v[28:29], s[34:35], s[34:35] clamp
    v_pk_fma_f32 v[30:31], v[30:31], s[34:35], s[34:35] clamp
    v_pk_fma_f32 v[56:57], v[24:25], v[56:57], v[24:25]
    s_waitcnt lgkmcnt(1)
    buffer_store_dwordx4 a[68:71], v114, s[24:27], s56 offen offset:0 sc0 sc1
    v_pk_fma_f32 v[58:59], v[26:27], v[58:59], v[26:27]
    v_pk_fma_f32 v[60:61], v[28:29], v[60:61], v[28:29]
    v_pk_fma_f32 v[62:63], v[30:31], v[62:63], v[30:31]
    v_rcp_f32 v56, v56
    v_rcp_f32 v57, v57
    s_waitcnt lgkmcnt(0)
    s_mov_b64 exec, 0xffff
    s_movk_i32 s30, 1024
    buffer_store_dwordx4 a[28:31], v115, s[24:27], s30 offen sc0 sc1
    s_mov_b64 exec, -1
    v_rcp_f32 v58, v58
    v_rcp_f32 v59, v59
    v_rcp_f32 v60, v60
    v_rcp_f32 v61, v61
    v_rcp_f32 v62, v62
    v_rcp_f32 v63, v63
    v_pk_add_f32 v[24:25], s[54:55], v[24:25] neg_lo:[0,1] neg_hi:[0,1]
    v_pk_add_f32 v[26:27], s[54:55], v[26:27] neg_lo:[0,1] neg_hi:[0,1]
    v_pk_add_f32 v[28:29], s[54:55], v[28:29] neg_lo:[0,1] neg_hi:[0,1]
    v_pk_add_f32 v[30:31], s[54:55], v[30:31] neg_lo:[0,1] neg_hi:[0,1]
    v_pk_mul_f32 v[24:25], v[24:25], v[56:57]
    v_pk_mul_f32 v[26:27], v[26:27], v[58:59]
    v_pk_mul_f32 v[28:29], v[28:29], v[60:61]
    v_pk_mul_f32 v[30:31], v[30:31], v[62:63]
    v_cvt_pk_bf16_f32 v56, v24, v25
    v_cvt_pk_bf16_f32 v57, v26, v27
    v_cvt_pk_bf16_f32 v60, v28, v29
    v_cvt_pk_bf16_f32 v61, v30, v31
    ds_write2st64_b64 v107, v[56:57], v[60:61] offset0:8 offset1:10
    v_pk_mul_f32 v[32:33], v[32:33], s[52:53]
    v_pk_mul_f32 v[34:35], v[34:35], s[52:53]
    v_pk_mul_f32 v[36:37], v[36:37], s[52:53]
    v_pk_mul_f32 v[38:39], v[38:39], s[52:53]
    v_pk_mul_f32 v[64:65], v[64:65], s[32:33]
    v_pk_mul_f32 v[66:67], v[66:67], s[32:33]
    v_pk_mul_f32 v[68:69], v[68:69], s[32:33]
    v_pk_mul_f32 v[70:71], v[70:71], s[32:33]
    s_waitcnt lgkmcnt(0)
    s_barrier
    v_exp_f32 v32, v32
    v_exp_f32 v33, v33
    ds_read_b128 a[4:7], v112 offset:9344
    v_exp_f32 v34, v34
    v_exp_f32 v35, v35
    ds_read_b128 a[68:71], v112 offset:10512
    v_exp_f32 v36, v36
    v_exp_f32 v37, v37
    ds_read_b128 a[28:31], v113 offset:10368
    v_exp_f32 v38, v38
    v_exp_f32 v39, v39
    v_exp_f32 v64, v64
    v_exp_f32 v65, v65
    v_exp_f32 v66, v66
    v_exp_f32 v67, v67
    v_exp_f32 v68, v68
    v_exp_f32 v69, v69
    v_exp_f32 v70, v70
    v_exp_f32 v71, v71
    s_waitcnt lgkmcnt(2)
    buffer_store_dwordx4 a[4:7], v114, s[24:27], 0 offen offset:1152 sc0 sc1
    v_pk_fma_f32 v[32:33], v[32:33], s[34:35], s[34:35] clamp
    v_pk_fma_f32 v[34:35], v[34:35], s[34:35], s[34:35] clamp
    v_pk_fma_f32 v[36:37], v[36:37], s[34:35], s[34:35] clamp
    v_pk_fma_f32 v[38:39], v[38:39], s[34:35], s[34:35] clamp
    v_pk_fma_f32 v[64:65], v[32:33], v[64:65], v[32:33]
    s_waitcnt lgkmcnt(1)
    buffer_store_dwordx4 a[68:71], v114, s[24:27], s56 offen offset:1152 sc0 sc1
    v_pk_fma_f32 v[66:67], v[34:35], v[66:67], v[34:35]
    v_pk_fma_f32 v[68:69], v[36:37], v[68:69], v[36:37]
    v_pk_fma_f32 v[70:71], v[38:39], v[70:71], v[38:39]
    v_rcp_f32 v64, v64
    v_rcp_f32 v65, v65
    s_waitcnt lgkmcnt(0)
    s_mov_b64 exec, 0xffff
    s_movk_i32 s30, 2176
    buffer_store_dwordx4 a[28:31], v115, s[24:27], s30 offen sc0 sc1
    s_mov_b64 exec, -1
    v_rcp_f32 v66, v66
    v_rcp_f32 v67, v67
    v_rcp_f32 v68, v68
    v_rcp_f32 v69, v69
    v_rcp_f32 v70, v70
    v_rcp_f32 v71, v71
    v_pk_add_f32 v[32:33], s[54:55], v[32:33] neg_lo:[0,1] neg_hi:[0,1]
    v_pk_add_f32 v[34:35], s[54:55], v[34:35] neg_lo:[0,1] neg_hi:[0,1]
    v_pk_add_f32 v[36:37], s[54:55], v[36:37] neg_lo:[0,1] neg_hi:[0,1]
    v_pk_add_f32 v[38:39], s[54:55], v[38:39] neg_lo:[0,1] neg_hi:[0,1]
    v_pk_mul_f32 v[32:33], v[32:33], v[64:65]
    v_pk_mul_f32 v[34:35], v[34:35], v[66:67]
    v_pk_mul_f32 v[36:37], v[36:37], v[68:69]
    v_pk_mul_f32 v[38:39], v[38:39], v[70:71]
    v_cvt_pk_bf16_f32 v64, v32, v33
    v_cvt_pk_bf16_f32 v65, v34, v35
    v_cvt_pk_bf16_f32 v68, v36, v37
    v_cvt_pk_bf16_f32 v69, v38, v39
    ds_write2st64_b64 v107, v[64:65], v[68:69] offset0:12 offset1:14
    s_waitcnt lgkmcnt(0)
    s_barrier
    ds_read_b128 a[4:7], v112 offset:18688
    ds_read_b128 a[68:71], v112 offset:19856
    ds_read_b128 a[28:31], v113 offset:19712
    ds_read_b128 a[116:119], v108 offset:6144
    ds_read_b128 a[40:43], v108 offset:14336
    ds_read_b128 a[84:87], v108 offset:22528
    ds_read_b128 a[72:75], v108 offset:30720
    ds_read_b64 a[0:1], v109 offset:3072
    s_waitcnt lgkmcnt(7)
    buffer_store_dwordx4 a[4:7], v114, s[24:27], 0 offen offset:2304 sc0 sc1
    s_waitcnt lgkmcnt(6)
    buffer_store_dwordx4 a[68:71], v114, s[24:27], s56 offen offset:2304 sc0 sc1
    s_waitcnt lgkmcnt(4)
    v_mfma_f32_16x16x32_bf16 v[32:35], a[76:79], a[116:119], 0
    s_waitcnt lgkmcnt(3)
    v_mfma_f32_16x16x32_bf16 v[32:35], a[32:35], a[40:43], v[32:35]
    s_waitcnt lgkmcnt(2)
    v_mfma_f32_16x16x32_bf16 v[32:35], a[92:95], a[84:87], v[32:35]
    s_waitcnt lgkmcnt(1)
    v_mfma_f32_16x16x32_bf16 v[32:35], a[60:63], a[72:75], v[32:35]
    s_waitcnt lgkmcnt(0)
    v_mfma_f32_16x16x32_bf16 v[32:35], a[88:91], a[0:3], v[32:35]
    v_mfma_f32_16x16x32_bf16 v[36:39], a[16:19], a[116:119], 0
    v_mfma_f32_16x16x32_bf16 v[36:39], a[12:15], a[40:43], v[36:39]
    v_mfma_f32_16x16x32_bf16 v[36:39], a[8:11], a[84:87], v[36:39]
    v_mfma_f32_16x16x32_bf16 v[36:39], a[48:51], a[72:75], v[36:39]
    v_mfma_f32_16x16x32_bf16 v[36:39], a[100:103], a[0:3], v[36:39]
    s_mov_b64 exec, 0xffff
    s_movk_i32 s30, 3328
    buffer_store_dwordx4 a[28:31], v115, s[24:27], s30 offen sc0 sc1
    s_mov_b64 exec, -1
    v_cvt_pk_bf16_f32 v32, v32, v33
    v_cvt_pk_bf16_f32 v33, v34, v35
    ds_write_b64 v110, v[32:33] offset:28032
    s_nop 1
    v_cvt_pk_bf16_f32 v36, v36, v37
    v_cvt_pk_bf16_f32 v37, v38, v39
    ds_write_b64 v110, v[36:37] offset:28064
    s_waitcnt lgkmcnt(0)
    s_barrier
    ds_read_b128 a[4:7], v112 offset:28032
    ds_read_b128 a[68:71], v112 offset:29200
    ds_read_b128 a[28:31], v113 offset:29056
    s_waitcnt lgkmcnt(2)
    buffer_store_dwordx4 a[4:7], v114, s[24:27], 0 offen offset:3456 sc0 sc1
    s_waitcnt lgkmcnt(1)
    buffer_store_dwordx4 a[68:71], v114, s[24:27], s56 offen offset:3456 sc0 sc1
    s_waitcnt lgkmcnt(0)
    s_mov_b64 exec, 0xffff
    s_movk_i32 s30, 4480
    buffer_store_dwordx4 a[28:31], v115, s[24:27], s30 offen sc0 sc1
    s_mov_b64 exec, -1
L_fin:
L_end:
L_last:
s_endpgm
.section .rodata,"a"
.p2align 6
.amdhsa_kernel standalone__autoregressive_conv_wavenet__speech_kernel
  .amdhsa_next_free_vgpr 256
  .amdhsa_next_free_sgpr 102
  .amdhsa_accum_offset 128
  .amdhsa_group_segment_fixed_size 0
  .amdhsa_kernarg_size 48
  .amdhsa_user_sgpr_count 2
  .amdhsa_user_sgpr_kernarg_segment_ptr 1
  .amdhsa_system_sgpr_workgroup_id_x 1
.end_amdhsa_kernel
```
